```python
import torch

def _softmax(x, axis=-1):
    return torch.softmax(x, dim=axis)
def _gelu(x):
    return torch.nn.functional.gelu(x, approximate="tanh")
def _silu(x):
    return torch.nn.functional.silu(x)
def _sigmoid(x):
    return torch.sigmoid(x)
def _layernorm(x, axis=-1, eps=1e-5):
    m = x.mean(dim=axis, keepdim=True)
    v = x.var(dim=axis, keepdim=True, unbiased=False)
    return (x - m) / torch.sqrt(v + eps)
def _scatter_add(tgt, idx, src, axis=0):
    return tgt.clone().index_add_(axis, idx, src)
def _segment_sum(src, seg, n):
    out = torch.zeros((n,) + src.shape[1:], dtype=src.dtype)
    return out.index_add_(0, seg, src)
def _pad(x, pw):
    flat = tuple(v for pair in reversed(pw) for v in pair)
    return torch.nn.functional.pad(x, flat)

kernel_name = 'concat_heads__spectral_gfnet__spectral_gfnet__prompt'

def setup_inputs():

    _w = (lambda a: (lambda t: t.to(torch.bfloat16) if t.is_floating_point() else t)(torch.as_tensor(a)))
    def _A_setup():
        B, S, D = 1, 2048, 1024
        Df = D // 2 + 1
        return {
            "x": _w((lambda *s: torch.randn(*s, dtype=torch.bfloat16) * 0.05)(B, S, D)),
            "w_r": _w((lambda *s: torch.randn(*s, dtype=torch.bfloat16) * 0.05)(S, Df) * 0.02),
            "w_i": _w((lambda *s: torch.randn(*s, dtype=torch.bfloat16) * 0.05)(S, Df) * 0.02),
        }
    _A_in = _A_setup()

    def _B_setup():
        B, S, D = 1, 2048, 1024
        Df = D // 2 + 1
        return {
            "x": _w((lambda *s: torch.randn(*s, dtype=torch.bfloat16) * 0.05)(B, S, D)),
            "w_r": _w((lambda *s: torch.randn(*s, dtype=torch.bfloat16) * 0.05)(S, Df) * 0.02),
            "w_i": _w((lambda *s: torch.randn(*s, dtype=torch.bfloat16) * 0.05)(S, Df) * 0.02),
        }
    _B_in = _B_setup()

    return {
        "A_x": _A_in["x"],
        "A_w_r": _A_in["w_r"],
        "A_w_i": _A_in["w_i"],
        "B_x": _B_in["x"],
        "B_w_r": _B_in["w_r"],
        "B_w_i": _B_in["w_i"],
    }

def reference(A_x, A_w_r, A_w_i, B_x, B_w_r, B_w_i):
    def _A_ref(x, w_r, w_i):
        B, S, D = x.shape
        X = (lambda x, axes=(-2,-1): torch.fft.rfft2(x.float(), dim=axes))(x, axes=(-2, -1))
        W = w_r + 1j * w_i
        X = X * W
        y = (lambda x, s, axes=(-2,-1): torch.fft.irfft2(x, s=s, dim=axes).to(torch.bfloat16))(X, (S, D), axes=(-2, -1))
        return y

    def _B_ref(x, w_r, w_i):
        B, S, D = x.shape
        X = (lambda x, axes=(-2,-1): torch.fft.rfft2(x.float(), dim=axes))(x, axes=(-2, -1))
        W = w_r + 1j * w_i
        X = X * W
        y = (lambda x, s, axes=(-2,-1): torch.fft.irfft2(x, s=s, dim=axes).to(torch.bfloat16))(X, (S, D), axes=(-2, -1))
        return y

    a = _A_ref(A_x, A_w_r, A_w_i)
    b = _B_ref(B_x, B_w_r, B_w_i)
    return torch.concatenate([a, b], axis=-1)
```

```asm
; @launch grid=(256,1,1) block=(512,1,1) lds=160320
.amdgcn_target "amdgcn-amd-amdhsa--gfx950"
.text
.globl concat_heads__spectral_gfnet__spectral_gfnet__prompt_kernel
.p2align 8
.type concat_heads__spectral_gfnet__spectral_gfnet__prompt_kernel,@function
concat_heads__spectral_gfnet__spectral_gfnet__prompt_kernel:
    s_cmp_ge_u32 s2, 256
    s_cbranch_scc1 L_end
    s_bfe_u32 s4, s2, 65539
    s_mul_i32 s34, s4, 24
    s_load_dwordx2 s[8:9], s[0:1], s34
    s_load_dwordx2 s[24:25], s[0:1], 64
    s_load_dwordx2 s[12:13], s[0:1], s34 offset:8
    s_load_dwordx2 s[16:17], s[0:1], s34 offset:16
    s_load_dwordx2 s[20:21], s[0:1], 48
    v_lshrrev_b32 v2, 6, v0
    s_getpc_b64 s[44:45]
L_pc:
    s_lshr_b32 s36, s2, 4
    v_readfirstlane_b32 s3, v2
    s_mov_b32 s46, L_end-L_pc
    s_mov_b32 s47, 0x20000
    v_lshlrev_b32 v3, 11, v2
    s_lshl_b32 s40, s36, 7
    buffer_load_dword v80, v3, s[44:47], s40 offen
    v_and_b32 v1, 63, v0
    s_and_b32 s35, s2, 7
    s_and_b32 s5, s2, 0x73
    s_and_b32 s39, s2, 4
    s_lshl1_add_u32 s5, s39, s5
    s_lshr_b32 s39, s2, 7
    s_lshl2_add_u32 s5, s39, s5
    s_and_b32 s6, s5, 31
    s_lshr_b32 s39, s5, 5
    s_lshl2_add_u32 s6, s6, s39
    v_lshlrev_b32 v81, 4, v1
    s_mov_b32 s10, 4194304
    s_mov_b32 s11, 0x20000
    s_and_b32 s31, s5, 4
    s_xor_b32 s31, s31, s3
    s_lshl_b32 s96, s31, 7
    s_add_u32 s96, s96, s6
    s_lshl_b32 s96, s96, 11
    s_add_u32 s97, s96, 0x200000
    s_lshl_b32 s52, s3, 12
    s_mov_b32 m0, s52
    s_lshr_b32 s37, s3, 1
    s_and_b32 s38, s3, 1
    s_lshl2_add_u32 s40, s37, s38
    s_lshl_b32 s40, s40, 1
    v_lshrrev_b32 v104, 5, v1
    v_and_b32 v105, 31, v1
    v_lshl_add_u32 v88, v104, 2, s40
    v_mul_u32_u24 v88, v88, v105
    v_add_u32 v89, v88, v105
    v_cvt_f32_u32 v88, v88
    v_cvt_f32_u32 v89, v89
    s_mov_b32 s40, 0x3d000000
    v_mul_f32 v90, s40, v88
    v_mul_f32 v91, s40, v89
    v_cos_f32 v96, v90
    v_cos_f32 v97, v91
    v_sin_f32 v98, v90
    v_sin_f32 v99, v91
    v_mul_f32 v88, s40, v90
    v_mul_f32 v89, s40, v91
    v_cos_f32 v92, v88
    v_cos_f32 v93, v89
    v_sin_f32 v94, v88
    v_sin_f32 v95, v89
    v_cvt_pk_bf16_f32 v100, v96, v97
    v_cvt_pk_bf16_f32 v101, v98, v99
    v_cvt_pk_bf16_f32 v102, -v98, -v99
    v_add_u32 v15, 145984, v81
    s_lshl_b32 s37, s37, 10
    s_lshl3_add_u32 s37, s38, s37
    v_add_u32 v88, s37, v15
    s_mul_i32 s37, s3, 0x104
    s_and_b32 s37, s37, 0x40c
    v_add_u32 v89, s37, v15
    s_waitcnt lgkmcnt(0)
    s_cmp_lg_u32 s4, 0
    s_cbranch_scc1 L_xlate
    buffer_load_dwordx4 v81, s[8:11], s96 offen nt lds
    buffer_load_dwordx4 v81, s[8:11], s96 offen offset:1024 nt lds
    s_add_u32 m0, s52, 2048
    s_nop 0
    buffer_load_dwordx4 v81, s[8:11], s97 offen nt lds
    buffer_load_dwordx4 v81, s[8:11], s97 offen offset:1024 nt lds
L_xlate:
    ds_write_b64 v88, v[92:93]
    ds_write_b64 v88, v[94:95] offset:4096
    ds_write_b32 v89, v100 offset:8192
    ds_write_b32 v89, v101 offset:10240
    ds_write_b32 v89, v102 offset:12288
    v_and_b32 v2, 15, v1
    v_lshrrev_b32 v3, 4, v1
    s_mov_b32 s40, 655360
    s_cmp_lg_u32 s3, 0
    s_waitcnt lgkmcnt(0)
    s_cbranch_scc1 L_noe
    s_load_dword s54, s[24:25], s40
L_noe:
    s_barrier
    s_cmp_eq_u32 s4, 0
    s_cbranch_scc1 L_xdone
    s_and_b32 s46, s3, 1
    s_lshl_b32 s46, s46, 4
    s_lshr_b32 s47, s3, 1
    v_add_u32 v160, s46, v2
    v_lshl_add_u32 v164, v160, 2, s47
    v_lshl_add_u32 v161, v3, 4, s47
    v_mul_u32_u24 v163, v161, v160
    v_mul_u32_u24 v165, v3, v164
    v_cvt_f32_u32 v162, v160
    v_cvt_f32_u32 v164, v164
    v_cvt_f32_u32 v163, v163
    v_cvt_f32_u32 v165, v165
    v_mul_f32 v163, 0x3c000000, v163
    v_mul_f32 v165, 0x3d000000, v165
    s_lshl_b32 s46, s3, 11
    s_add_u32 s46, s46, 111104
    v_lshl_add_u32 v166, v1, 4, s46
    v_fmamk_f32 v128, v162, 0x00000000, v163
    v_fmamk_f32 v129, v162, 0x3d000000, v163
    v_fmamk_f32 v130, v162, 0x3d800000, v163
    v_fmamk_f32 v131, v162, 0x3dc00000, v163
    v_fmamk_f32 v132, v162, 0x3f000000, v163
    v_fmamk_f32 v133, v162, 0x3f080000, v163
    v_fmamk_f32 v134, v162, 0x3f100000, v163
    v_fmamk_f32 v135, v162, 0x3f180000, v163
    v_fmamk_f32 v136, v164, 0x00000000, v165
    v_fmamk_f32 v137, v164, 0x3c000000, v165
    v_fmamk_f32 v138, v164, 0x3c800000, v165
    v_fmamk_f32 v139, v164, 0x3cc00000, v165
    v_fmamk_f32 v140, v164, 0x3e000000, v165
    v_fmamk_f32 v141, v164, 0x3e080000, v165
    v_fmamk_f32 v142, v164, 0x3e100000, v165
    v_fmamk_f32 v143, v164, 0x3e180000, v165
    v_cos_f32 v144, v128
    v_sin_f32 v168, v128
    v_cos_f32 v145, v129
    v_sin_f32 v169, v129
    v_cos_f32 v146, v130
    v_sin_f32 v170, v130
    v_cos_f32 v147, v131
    v_sin_f32 v171, v131
    v_cos_f32 v148, v132
    v_sin_f32 v172, v132
    v_cos_f32 v149, v133
    v_sin_f32 v173, v133
    v_cos_f32 v150, v134
    v_sin_f32 v174, v134
    v_cos_f32 v151, v135
    v_sin_f32 v175, v135
    v_cos_f32 v152, v136
    v_sin_f32 v176, v136
    v_cos_f32 v153, v137
    v_sin_f32 v177, v137
    v_cos_f32 v154, v138
    v_sin_f32 v178, v138
    v_cos_f32 v155, v139
    v_sin_f32 v179, v139
    v_cos_f32 v156, v140
    v_sin_f32 v180, v140
    v_cos_f32 v157, v141
    v_sin_f32 v181, v141
    v_cos_f32 v158, v142
    v_sin_f32 v182, v142
    v_cos_f32 v159, v143
    v_sin_f32 v183, v143
    v_cvt_pk_bf16_f32 v128, v144, v145
    v_cvt_pk_bf16_f32 v132, v168, v169
    v_cvt_pk_bf16_f32 v129, v146, v147
    v_cvt_pk_bf16_f32 v133, v170, v171
    v_cvt_pk_bf16_f32 v130, v148, v149
    v_cvt_pk_bf16_f32 v134, v172, v173
    v_cvt_pk_bf16_f32 v131, v150, v151
    v_cvt_pk_bf16_f32 v135, v174, v175
    v_cvt_pk_bf16_f32 v136, v152, v153
    v_cvt_pk_bf16_f32 v140, v176, v177
    v_cvt_pk_bf16_f32 v137, v154, v155
    v_cvt_pk_bf16_f32 v141, v178, v179
    v_cvt_pk_bf16_f32 v138, v156, v157
    v_cvt_pk_bf16_f32 v142, v180, v181
    v_cvt_pk_bf16_f32 v139, v158, v159
    v_cvt_pk_bf16_f32 v143, v182, v183
    ds_write_b128 v166, v[128:131] offset:0
    ds_write_b128 v166, v[132:135] offset:1024
    ds_write_b128 v166, v[136:139] offset:16384
    ds_write_b128 v166, v[140:143] offset:17408
    s_barrier
    buffer_load_dwordx4 v81, s[8:11], s96 offen nt lds
    buffer_load_dwordx4 v81, s[8:11], s96 offen offset:1024 nt lds
    s_add_u32 m0, s52, 2048
    s_nop 0
    buffer_load_dwordx4 v81, s[8:11], s97 offen nt lds
    buffer_load_dwordx4 v81, s[8:11], s97 offen offset:1024 nt lds
    s_cmp_lg_u32 s3, 0
    s_cbranch_scc1 L_xdone
    s_lshl_b32 s37, s5, 8
    s_add_u32 s37, s37, 98304
    s_mov_b32 s50, 0
    s_waitcnt lgkmcnt(0)
    s_mul_i32 s51, s54, 0x9E3779B1
    s_add_u32 s51, s51, 0x7F4A7C15
    s_atomic_swap_x2 s[50:51], s[24:25], s37
L_xdone:
    ds_read_b128 v[48:51], v15 offset:8192
    ds_read_b128 v[52:55], v15 offset:9216
    ds_read_b128 v[56:59], v15 offset:10240
    ds_read_b128 v[60:63], v15 offset:11264
    ds_read_b128 v[64:67], v15 offset:12288
    ds_read_b128 v[68:71], v15 offset:13312
    ds_read_b128 v[16:19], v15 offset:0
    ds_read_b128 v[32:35], v15 offset:4096
    ds_read_b128 v[20:23], v15 offset:1024
    ds_read_b128 v[36:39], v15 offset:5120
    ds_read_b128 v[24:27], v15 offset:2048
    ds_read_b128 v[40:43], v15 offset:6144
    ds_read_b128 v[28:31], v15 offset:3072
    ds_read_b128 v[44:47], v15 offset:7168
    s_lshr_b32 s37, s36, 3
    s_lshl1_add_u32 s7, s35, s37
    s_and_b32 s32, s36, 7
    s_mov_b32 s14, 2101248
    s_mov_b32 s15, 0x20000
    s_mov_b32 s18, 2101248
    s_mov_b32 s19, 0x20000
    s_cmp_lg_u32 s3, 1
    s_cbranch_scc1 L_nogather
    v_lshrrev_b32 v9, 2, v2
    v_and_b32 v10, 1, v2
    v_lshl_add_u32 v9, v9, 1, v10
    v_and_b32 v10, 2, v2
    v_lshl_add_u32 v9, v10, 2, v9
    v_mul_u32_u24 v9, 1026, v9
    s_mul_i32 s37, s5, 16416
    buffer_load_ushort v11, v9, s[12:15], s37 offen offset:1024
    buffer_load_ushort v12, v9, s[16:19], s37 offen offset:1024
L_nogather:
    s_mul_i32 s98, s7, 1026
    s_lshl_b32 s34, s32, 7
    s_add_u32 s98, s98, s34
    s_andn2_b32 s98, s98, 15
    v_add_u32 v88, s3, v1
    v_mul_u32_u24 v89, 57, v88
    v_lshrrev_b32 v89, 9, v89
    v_mul_u32_u24 v89, 16272, v89
    v_lshl_add_u32 v84, v88, 4, v89
    v_bfe_u32 v88, v1, 2, 2
    v_lshl_add_u32 v88, v104, 2, v88
    v_lshl_add_u32 v88, v88, 6, s52
    v_and_b32 v90, 16, v1
    v_lshl_add_u32 v88, v90, 1, v88
    v_and_b32 v90, 3, v1
    v_lshl_add_u32 v4, v90, 3, v88
    s_lshl_b32 s53, s4, 3
    s_mul_i32 s30, s4, 32768
    s_add_u32 s30, s30, 65536
    s_mov_b32 s50, 0
    s_mov_b32 s100, 1
    s_lshr_b32 s56, s5, 5
    s_lshl2_add_u32 s56, s3, s56
    s_mul_i32 s56, s56, 256
    s_add_u32 s56, s56, s30
    s_lshr_b32 s57, s5, 4
    s_lshl3_add_u32 s57, s3, s57
    s_mul_i32 s57, s57, 256
    s_add_u32 s57, s57, s30
    s_add_u32 s57, s57, 8192
    s_and_b32 s37, s5, 0
    s_lshl_b32 s37, s37, 16
    s_add_u32 s57, s57, s37
    s_mov_b32 s26, 2097152
    s_mov_b32 s27, 0x20000
    s_mov_b32 s22, 8388608
    s_mov_b32 s23, 0x20000
    s_lshl_b32 s42, s96, 1
    s_lshl_b32 s37, s4, 11
    s_add_u32 s42, s42, s37
    s_add_u32 s43, s42, 4194304
    s_mul_i32 s37, s3, 640
    s_add_u32 s37, s37, 32768
    v_mul_u32_u24 v8, 10368, v3
    v_lshl_add_u32 v8, v2, 3, v8
    v_add_u32 v8, s37, v8
    v_lshlrev_b32 v9, 9, v3
    v_lshl_add_u32 v9, v2, 4, v9
    v_mov_b32 v14, 143872
    v_lshlrev_b32 v13, 2, v0
    v_add_u32 v13, 143936, v13
    v_mov_b32 v86, 0
    v_mov_b32 v87, 0
    v_mov_b32 v237, 0
    v_mov_b32 v242, 0
    s_mov_b32 s55, 2
    s_cmp_ge_u32 s3, 4
    s_cbranch_scc1 L_setup3
L_ret1:
    s_mul_i32 s46, s3, 114912
    s_add_u32 s46, s46, s98
    s_lshl_b32 s47, s3, 10
    s_add_u32 m0, s47, 74240
    s_nop 0
    buffer_load_dwordx4 v84, s[12:15], s46 offen nt lds
    s_add_u32 m0, s47, 92672
    s_nop 0
    buffer_load_dwordx4 v84, s[16:19], s46 offen nt lds
    s_add_u32 m0, s47, 83456
    s_add_u32 s101, s46, 1050624
    buffer_load_dwordx4 v84, s[12:15], s101 offen nt lds
L_noearly:
    ds_write_b64 v14, v[86:87]
    ds_write_b64 v14, v[86:87] offset:8
    ds_write_b32 v13, v86
    s_mul_i32 s37, s5, 256
    s_add_u32 s37, s37, s30
    s_waitcnt vmcnt(5)
    s_cmp_eq_u32 s3, 1
    s_cbranch_scc1 L_xw1
    s_waitcnt vmcnt(3)
L_xw1:
    s_nop 0
    ds_read_b64_tr_b16 v[112:113], v4 offset:0
    ds_read_b64_tr_b16 v[114:115], v4 offset:512
    ds_read_b64_tr_b16 v[116:117], v4 offset:1024
    ds_read_b64_tr_b16 v[118:119], v4 offset:1536
    ds_read_b64_tr_b16 v[120:121], v4 offset:2048
    ds_read_b64_tr_b16 v[122:123], v4 offset:2560
    ds_read_b64_tr_b16 v[124:125], v4 offset:3072
    ds_read_b64_tr_b16 v[126:127], v4 offset:3584
    s_or_b32 s34, s3, s4
    s_waitcnt lgkmcnt(0)
    v_mfma_f32_32x32x16_bf16 v[128:143], v[112:115], v[48:51], 0
    s_cbranch_scc1 L_e1
    s_mul_i32 s51, s54, 0x9E3779B1
    s_add_u32 s51, s51, 0x7F4A7C15
    s_atomic_swap_x2 s[50:51], s[24:25], s37
    s_branch L_e2
L_e1:
    s_load_dword s54, s[24:25], s40
L_e2:
    v_mfma_f32_32x32x16_bf16 v[128:143], v[116:119], v[52:55], v[128:143]
    s_mul_i32 s34, s31, 5184
    s_add_u32 s34, s34, 32768
    v_mul_u32_u24 v92, 20, v90
    v_lshrrev_b32 v93, 2, v105
    v_mul_u32_u24 v94, 160, v104
    v_add3_u32 v92, v92, v93, v94
    v_mfma_f32_32x32x16_bf16 v[128:143], v[120:123], v[56:59], v[128:143]
    v_lshl_add_u32 v5, v92, 3, s34
    v_sub_u32 v91, 32, v105
    v_and_b32 v92, 3, v91
    v_mul_u32_u24 v92, 20, v92
    v_lshrrev_b32 v93, 2, v91
    v_sub_u32 v94, 160, v94
    v_mfma_f32_32x32x16_bf16 v[128:143], v[124:127], v[60:63], v[128:143]
    v_add3_u32 v92, v92, v93, v94
    v_lshl_add_u32 v6, v92, 3, s34
    v_and_b32_e64 v91, 32, v91
    v_lshl_add_u32 v7, v91, 4, v6
    v_lshrrev_b32 v88, 1, v2
    v_and_b32 v89, 1, v88
    v_mfma_f32_32x32x16_bf16 v[144:159], v[112:115], v[64:67], 0
    s_bfe_u32 s34, s5, 0x10002
    v_and_b32 v90, 1, v2
    v_xor_b32 v90, s34, v90
    v_sub_u32 v90, v90, v89
    v_cvt_f32_i32 v90, v90
    v_mov_b32 v91, 0x3e000000
    v_mfma_f32_32x32x16_bf16 v[144:159], v[116:119], v[68:71], v[144:159]
    v_mul_f32_e64 v192, v128, v16
    v_mul_f32_e64 v208, -v128, v32
    v_mul_f32_e64 v193, v129, v17
    v_mul_f32_e64 v209, -v129, v33
    v_mul_f32_e64 v194, v130, v18
    v_mul_f32_e64 v210, -v130, v34
    v_mfma_f32_32x32x16_bf16 v[144:159], v[120:123], v[48:51], v[144:159]
    v_mul_f32_e64 v195, v131, v19
    v_mul_f32_e64 v211, -v131, v35
    v_mul_f32_e64 v196, v132, v20
    v_mul_f32_e64 v212, -v132, v36
    v_mul_f32_e64 v197, v133, v21
    v_mul_f32_e64 v213, -v133, v37
    v_mfma_f32_32x32x16_bf16 v[144:159], v[124:127], v[52:55], v[144:159]
    v_mul_f32_e64 v198, v134, v22
    v_mul_f32_e64 v214, -v134, v38
    v_mul_f32_e64 v199, v135, v23
    v_mul_f32_e64 v215, -v135, v39
    v_mul_f32_e64 v200, v136, v24
    v_mul_f32_e64 v216, -v136, v40
    v_mul_f32_e64 v201, v137, v25
    v_mul_f32_e64 v217, -v137, v41
    v_mul_f32_e64 v202, v138, v26
    v_mul_f32_e64 v218, -v138, v42
    v_mul_f32_e64 v203, v139, v27
    v_mul_f32_e64 v219, -v139, v43
    v_mul_f32_e64 v204, v140, v28
    v_mul_f32_e64 v220, -v140, v44
    v_mul_f32_e64 v205, v141, v29
    v_mul_f32_e64 v221, -v141, v45
    v_mul_f32_e64 v206, v142, v30
    v_mul_f32_e64 v222, -v142, v46
    v_mul_f32_e64 v207, v143, v31
    v_mul_f32_e64 v223, -v143, v47
    v_fmac_f32 v192, v144, v32
    v_fmac_f32 v208, v144, v16
    v_fmac_f32 v193, v145, v33
    v_fmac_f32 v209, v145, v17
    v_cvt_pk_bf16_f32 v112, v192, v193
    v_cvt_pk_bf16_f32 v120, v208, v209
    v_fmac_f32 v194, v146, v34
    v_fmac_f32 v210, v146, v18
    v_fmac_f32 v195, v147, v35
    v_fmac_f32 v211, v147, v19
    v_cvt_pk_bf16_f32 v113, v194, v195
    v_cvt_pk_bf16_f32 v121, v210, v211
    v_fmac_f32 v196, v148, v36
    v_fmac_f32 v212, v148, v20
    v_fmac_f32 v197, v149, v37
    v_fmac_f32 v213, v149, v21
    v_cvt_pk_bf16_f32 v114, v196, v197
    v_cvt_pk_bf16_f32 v122, v212, v213
    v_fmac_f32 v198, v150, v38
    v_fmac_f32 v214, v150, v22
    v_fmac_f32 v199, v151, v39
    v_fmac_f32 v215, v151, v23
    v_cvt_pk_bf16_f32 v115, v198, v199
    v_cvt_pk_bf16_f32 v123, v214, v215
    v_fmamk_f32 v90, v90, 0x3e800000, v91
    v_mfma_f32_32x32x16_bf16 v[160:175], v[48:51], v[112:115], 0
    v_fmac_f32 v200, v152, v40
    v_fmac_f32 v216, v152, v24
    v_fmac_f32 v201, v153, v41
    v_fmac_f32 v217, v153, v25
    v_cvt_pk_bf16_f32 v116, v200, v201
    v_cvt_pk_bf16_f32 v124, v216, v217
    v_mfma_f32_32x32x16_bf16 v[176:191], v[64:67], v[112:115], 0
    v_fmac_f32 v202, v154, v42
    v_fmac_f32 v218, v154, v26
    v_fmac_f32 v203, v155, v43
    v_fmac_f32 v219, v155, v27
    v_cvt_pk_bf16_f32 v117, v202, v203
    v_cvt_pk_bf16_f32 v125, v218, v219
    v_mfma_f32_32x32x16_bf16 v[160:175], v[56:59], v[120:123], v[160:175]
    v_fmac_f32 v204, v156, v44
    v_fmac_f32 v220, v156, v28
    v_fmac_f32 v205, v157, v45
    v_fmac_f32 v221, v157, v29
    v_cvt_pk_bf16_f32 v118, v204, v205
    v_cvt_pk_bf16_f32 v126, v220, v221
    v_mfma_f32_32x32x16_bf16 v[176:191], v[48:51], v[120:123], v[176:191]
    v_fmac_f32 v206, v158, v46
    v_fmac_f32 v222, v158, v30
    v_fmac_f32 v207, v159, v47
    v_fmac_f32 v223, v159, v31
    v_cvt_pk_bf16_f32 v119, v206, v207
    v_cvt_pk_bf16_f32 v127, v222, v223
    v_mul_u32_u24 v89, 0x8000, v89
    v_mfma_f32_32x32x16_bf16 v[160:175], v[52:55], v[116:119], v[160:175]
    v_lshl_or_b32 v89, v89, 16, v89
    v_cvt_f32_u32_e64 v88, v88
    v_add_f32 v91, 0x41000000, v88
    v_lshl_add_u32 v92, v3, 8, s6
    v_cvt_f32_u32_e64 v92, v92
    v_mul_f32 v92, 0x3a000000, v92
    v_mfma_f32_32x32x16_bf16 v[176:191], v[68:71], v[116:119], v[176:191]
    v_add_f32 v93, 0x3d800000, v92
    v_fma_f32 v96, v92, v88, v90
    v_fma_f32 v99, v93, v88, v90
    v_fma_f32 v102, v92, v91, v90
    v_fma_f32 v105, v93, v91, v90
    v_mfma_f32_32x32x16_bf16 v[160:175], v[60:63], v[124:127], v[160:175]
    v_cos_f32 v97, v96
    v_sin_f32 v98, v96
    v_cos_f32_e64 v100, v99
    v_mfma_f32_32x32x16_bf16 v[176:191], v[52:55], v[124:127], v[176:191]
    v_sin_f32 v101, v99
    v_cos_f32 v103, v102
    v_sin_f32 v104, v102
    v_cos_f32 v106, v105
    v_sin_f32_e64 v107, v105
    v_cvt_pk_bf16_f32 v72, v97, v98
    v_cvt_pk_bf16_f32 v73, v98, v97
    v_xor_b32_e64 v73, v89, v73
    v_cvt_pk_bf16_f32 v74, v100, v101
    v_cvt_pk_bf16_f32 v75, v101, v100
    v_xor_b32_e64 v75, v89, v75
    v_cvt_pk_bf16_f32 v76, v103, v104
    v_cvt_pk_bf16_f32 v192, v160, v176
    v_cvt_pk_bf16_f32 v193, v161, v177
    v_cvt_pk_bf16_f32 v194, v162, v178
    v_cvt_pk_bf16_f32 v195, v163, v179
    v_cvt_pk_bf16_f32 v196, v164, v180
    v_cvt_pk_bf16_f32 v197, v165, v181
    v_cvt_pk_bf16_f32 v198, v166, v182
    v_cvt_pk_bf16_f32 v199, v167, v183
    v_cvt_pk_bf16_f32 v200, v168, v184
    v_cvt_pk_bf16_f32 v201, v169, v185
    v_cvt_pk_bf16_f32 v202, v170, v186
    v_cvt_pk_bf16_f32 v203, v171, v187
    v_cvt_pk_bf16_f32 v204, v172, v188
    v_cvt_pk_bf16_f32 v205, v173, v189
    v_cvt_pk_bf16_f32 v206, v174, v190
    v_cvt_pk_bf16_f32 v207, v175, v191
    ds_write_b32 v5, v192 offset:0
    ds_write_b32 v5, v193 offset:64
    ds_write_b32 v5, v194 offset:640
    ds_write_b32 v5, v195 offset:704
    ds_write_b32 v5, v196 offset:2560
    ds_write_b32 v5, v197 offset:2624
    ds_write_b32 v5, v198 offset:3200
    ds_write_b32 v5, v199 offset:3264
    ds_write_b32 v7, v200 offset:3268
    ds_write_b32 v6, v201 offset:3204
    ds_write_b32 v7, v202 offset:2628
    ds_write_b32 v6, v203 offset:2564
    ds_write_b32 v7, v204 offset:708
    ds_write_b32 v6, v205 offset:644
    ds_write_b32 v7, v206 offset:68
    ds_write_b32 v6, v207 offset:4
    s_mov_b64 exec, 1
    ds_write_b32 v5, v192 offset:4
    ds_write_b32 v5, v200 offset:5120
    s_mov_b64 exec, -1
    v_cvt_pk_bf16_f32 v77, v104, v103
    v_xor_b32_e64 v77, v89, v77
    v_cvt_pk_bf16_f32 v78, v106, v107
    v_cvt_pk_bf16_f32 v79, v107, v106
    v_xor_b32_e64 v79, v89, v79
    v_mul_u32_u24 v88, 10368, v3
    v_lshlrev_b32_e64 v90, 4, v3
    s_cmp_lg_u32 s3, 1
    s_cbranch_scc1 L_nosp0
    s_lshl4_add_u32 s34, s53, s5
    s_lshl_b32 s34, s34, 7
    s_add_u32 s34, s34, 196608
    v_lshlrev_b32 v89, 2, v1
    s_waitcnt vmcnt(3)
    v_lshl_or_b32 v11, v12, 16, v11
    s_mov_b64 exec, 0xffff
    buffer_store_dword v11, v89, s[24:27], s34 offen offset:64 sc1
    s_mov_b64 exec, -1
L_nosp0:
    s_nop 0
    s_waitcnt lgkmcnt(0)
    s_barrier
    ds_read_b64 v[112:113], v8 offset:0
    ds_read_b64 v[114:115], v8 offset:5184
    ds_read_b64 v[116:117], v8 offset:160
    ds_read_b64 v[118:119], v8 offset:5344
    ds_read_b64 v[120:121], v8 offset:320
    ds_read_b64 v[122:123], v8 offset:5504
    ds_read_b64 v[124:125], v8 offset:480
    ds_read_b64 v[126:127], v8 offset:5664
    ds_read_b64 v[176:177], v88 offset:37888
    ds_read_b64 v[178:179], v88 offset:43072
    s_mul_i32 s51, s54, 0x9E3779B1
    s_add_u32 s51, s51, 0x7F4A7C15
    s_waitcnt lgkmcnt(8)
    v_mfma_f32_16x16x32_bf16 v[128:131], v[72:75], v[112:115], 0
    s_waitcnt lgkmcnt(6)
    v_mfma_f32_16x16x32_bf16 v[136:139], v[72:75], v[116:119], 0
    s_waitcnt lgkmcnt(4)
    v_mfma_f32_16x16x32_bf16 v[144:147], v[72:75], v[120:123], 0
    s_waitcnt lgkmcnt(2)
    v_mfma_f32_16x16x32_bf16 v[152:155], v[72:75], v[124:127], 0
    v_mfma_f32_16x16x32_bf16 v[132:135], v[76:79], v[112:115], 0
    v_mfma_f32_16x16x32_bf16 v[140:143], v[76:79], v[116:119], 0
    v_mfma_f32_16x16x32_bf16 v[148:151], v[76:79], v[120:123], 0
    v_mfma_f32_16x16x32_bf16 v[156:159], v[76:79], v[124:127], 0
    s_waitcnt lgkmcnt(0)
    s_mov_b64 s[48:49], 0
    s_atomic_or_x2 s[48:49], s[24:25], s56 glc
    v_cvt_pk_bf16_f32 v196, v128, v136
    v_cvt_pk_bf16_f32 v198, v129, v137
    v_mfma_f32_16x16x32_bf16 v[160:163], v[72:75], v[176:179], 0
    v_cvt_pk_bf16_f32 v197, v144, v152
    v_cvt_pk_bf16_f32 v199, v145, v153
    v_cvt_pk_bf16_f32 v200, v130, v138
    v_cvt_pk_bf16_f32 v202, v131, v139
    v_mfma_f32_16x16x32_bf16 v[164:167], v[76:79], v[176:179], 0
    v_cvt_pk_bf16_f32 v201, v146, v154
    v_cvt_pk_bf16_f32 v203, v147, v155
    buffer_store_dwordx4 v[196:199], v9, s[20:23], s42 offen offset:0 sc1
    buffer_store_dwordx4 v[200:203], v9, s[20:23], s42 offen offset:256 sc1
    v_cvt_pk_bf16_f32 v204, v132, v140
    v_cvt_pk_bf16_f32 v206, v133, v141
    v_cvt_pk_bf16_f32 v205, v148, v156
    v_cvt_pk_bf16_f32 v207, v149, v157
    v_cvt_pk_bf16_f32 v208, v134, v142
    v_cvt_pk_bf16_f32 v210, v135, v143
    v_cvt_pk_bf16_f32 v209, v150, v158
    v_cvt_pk_bf16_f32 v211, v151, v159
    buffer_store_dwordx4 v[204:207], v9, s[20:23], s43 offen offset:0 sc1
    buffer_store_dwordx4 v[208:211], v9, s[20:23], s43 offen offset:256 sc1
    s_cmp_lg_u32 s3, 1
    s_cbranch_scc1 L_nosp1
    v_cvt_pk_bf16_f32 v192, v160, v162
    v_cvt_pk_bf16_f32 v193, v164, v166
    v_cvt_pk_bf16_f32 v194, v161, v163
    v_cvt_pk_bf16_f32 v195, v165, v167
    s_mov_b32 exec_lo, 0x00010001
    s_mov_b32 exec_hi, 0x00010001
    buffer_store_dwordx4 v[192:195], v90, s[24:27], s34 offen sc1
    s_mov_b64 exec, -1
L_nosp1:
    s_barrier
    s_cmp_lt_u32 s3, 4
    s_cbranch_scc1 L_notab2
    ds_read_b128 v[48:51], v244 offset:8192
    ds_read_b128 v[52:55], v244 offset:9216
    ds_read_b128 v[56:59], v244 offset:10240
    ds_read_b128 v[60:63], v244 offset:11264
    ds_read_b128 v[64:67], v244 offset:12288
    ds_read_b128 v[68:71], v244 offset:13312
    ds_read_b128 v[16:19], v244 offset:0
    ds_read_b128 v[32:35], v244 offset:4096
    ds_read_b128 v[20:23], v244 offset:1024
    ds_read_b128 v[36:39], v244 offset:5120
    ds_read_b128 v[24:27], v244 offset:2048
    ds_read_b128 v[40:43], v244 offset:6144
    ds_read_b128 v[28:31], v244 offset:3072
    ds_read_b128 v[44:47], v244 offset:7168
L_notab2:
    s_mov_b32 s55, 1
    s_mov_b32 s33, 0x8000
L_val1:
    s_waitcnt lgkmcnt(0)
    s_cmp_eq_u32 s49, s51
    s_cbranch_scc1 L_val1_out
    s_mov_b64 s[48:49], 0
    s_atomic_or_x2 s[48:49], s[24:25], s56 glc
    s_sub_u32 s33, s33, 1
    s_cbranch_scc0 L_val1
    s_waitcnt lgkmcnt(0)
L_val1_out:
    s_waitcnt vmcnt(0)
    s_atomic_add s100, s[24:25], s56
    s_cmp_ge_u32 s3, 4
    s_cbranch_scc1 L_helper
    v_add_u32 v88, 8, v1
    v_mul_u32_u24 v89, 57, v88
    v_lshrrev_b32 v89, 9, v89
    v_mul_u32_u24 v89, 16272, v89
    v_lshl_add_u32 v85, v88, 4, v89
    v_add_u32 v85, 919296, v85
    s_mul_i32 s101, s3, 9216
    s_add_u32 m0, s101, 82432
    s_and_b32 s101, s3, 1
    s_mul_i32 s101, s101, 1050624
    s_add_u32 s101, s101, s98
    s_bitcmp1_b32 s3, 1
    s_cbranch_scc1 L_t1_0
    buffer_load_dwordx4 v85, s[12:15], s101 offen nt lds
    s_branch L_t2_0
L_t1_0:
    buffer_load_dwordx4 v85, s[16:19], s101 offen nt lds
L_t2_0:
    v_add_u32 v108, s3, v1
    v_add_u32 v108, 4, v108
    v_mul_u32_u24 v109, 57, v108
    v_lshrrev_b32_e64 v109, 9, v109
    v_mul_u32_u24 v109, 16272, v109
    v_lshl_add_u32 v83, v108, 4, v109
    s_mul_i32 s46, s3, 114912
    s_add_u32 s46, s46, s98
    s_lshl_b32 s47, s3, 10
    s_add_u32 m0, s47, 101888
    s_add_u32 s101, s46, 1050624
    buffer_load_dwordx4 v84, s[16:19], s101 offen nt lds
    s_add_u32 s46, s46, 459648
    s_add_u32 s47, s47, 4096
    s_add_u32 m0, s47, 101888
    s_add_u32 s101, s46, 1050624
    buffer_load_dwordx4 v83, s[16:19], s101 offen nt lds
    s_cmp_lg_u32 s4, 0
    s_cbranch_scc1 L_genskip
    s_mov_b32 s101, s3
L_gen:
    s_and_b32 s46, s101, 1
    s_lshl_b32 s46, s46, 4
    s_lshr_b32 s47, s101, 1
    v_add_u32_e64 v160, s46, v2
    v_lshl_add_u32 v164, v160, 2, s47
    v_lshl_add_u32 v161, v3, 4, s47
    v_mul_u32_u24 v163, v161, v160
    v_mul_u32_u24 v165, v3, v164
    v_cvt_f32_u32 v162, v160
    v_cvt_f32_u32 v164, v164
    v_cvt_f32_u32 v163, v163
    v_cvt_f32_u32 v165, v165
    v_mul_f32 v163, 0x3c000000, v163
    v_mul_f32 v165, 0x3d000000, v165
    s_lshl_b32 s46, s101, 11
    s_nop 0
    s_add_u32 s46, s46, 111104
    v_lshl_add_u32 v166, v1, 4, s46
    v_fmamk_f32 v128, v162, 0x00000000, v163
    v_fmamk_f32 v129, v162, 0x3d000000, v163
    v_fmamk_f32 v130, v162, 0x3d800000, v163
    v_fmamk_f32 v131, v162, 0x3dc00000, v163
    v_fmamk_f32 v132, v162, 0x3f000000, v163
    v_fmamk_f32 v133, v162, 0x3f080000, v163
    v_fmamk_f32 v134, v162, 0x3f100000, v163
    v_fmamk_f32 v135, v162, 0x3f180000, v163
    v_fmamk_f32 v136, v164, 0x00000000, v165
    v_fmamk_f32 v137, v164, 0x3c000000, v165
    v_fmamk_f32 v138, v164, 0x3c800000, v165
    v_fmamk_f32 v139, v164, 0x3cc00000, v165
    v_fmamk_f32 v140, v164, 0x3e000000, v165
    v_fmamk_f32 v141, v164, 0x3e080000, v165
    v_fmamk_f32 v142, v164, 0x3e100000, v165
    v_fmamk_f32 v143, v164, 0x3e180000, v165
    v_cos_f32 v144, v128
    v_sin_f32 v168, v128
    v_cos_f32 v145, v129
    v_sin_f32 v169, v129
    v_cos_f32 v146, v130
    v_sin_f32 v170, v130
    v_cos_f32 v147, v131
    v_sin_f32 v171, v131
    v_cos_f32 v148, v132
    v_sin_f32 v172, v132
    v_cos_f32 v149, v133
    v_sin_f32 v173, v133
    v_cos_f32 v150, v134
    v_sin_f32 v174, v134
    v_cos_f32 v151, v135
    v_sin_f32 v175, v135
    v_cos_f32 v152, v136
    v_sin_f32 v176, v136
    v_cos_f32 v153, v137
    v_sin_f32 v177, v137
    v_cos_f32 v154, v138
    v_sin_f32 v178, v138
    v_cos_f32 v155, v139
    v_sin_f32 v179, v139
    v_cos_f32 v156, v140
    v_sin_f32 v180, v140
    v_cos_f32 v157, v141
    v_sin_f32 v181, v141
    v_cos_f32 v158, v142
    v_sin_f32 v182, v142
    v_cos_f32 v159, v143
    v_sin_f32 v183, v143
    v_cvt_pk_bf16_f32 v128, v144, v145
    v_cvt_pk_bf16_f32 v132, v168, v169
    v_cvt_pk_bf16_f32 v129, v146, v147
    v_cvt_pk_bf16_f32 v133, v170, v171
    v_cvt_pk_bf16_f32 v130, v148, v149
    v_cvt_pk_bf16_f32 v134, v172, v173
    v_cvt_pk_bf16_f32 v131, v150, v151
    v_cvt_pk_bf16_f32 v135, v174, v175
    v_cvt_pk_bf16_f32 v136, v152, v153
    v_cvt_pk_bf16_f32 v140, v176, v177
    v_cvt_pk_bf16_f32 v137, v154, v155
    v_cvt_pk_bf16_f32 v141, v178, v179
    v_cvt_pk_bf16_f32 v138, v156, v157
    v_cvt_pk_bf16_f32 v142, v180, v181
    v_cvt_pk_bf16_f32 v139, v158, v159
    v_cvt_pk_bf16_f32 v143, v182, v183
    ds_write_b128 v166, v[128:131] offset:0
    ds_write_b128 v166, v[132:135] offset:1024
    ds_write_b128 v166, v[136:139] offset:16384
    ds_write_b128 v166, v[140:143] offset:17408
    s_add_u32 s101, s101, 4
    s_cmp_lt_u32 s101, 8
    s_cbranch_scc1 L_gen
L_genskip:
    v_mov_b32_e64 v15, 1
    s_mov_b64 exec, 1
    ds_add_u32 v14, v15 offset:12
    s_mov_b64 exec, -1
    s_mov_b32 s38, 0
    s_and_b32 s40, s7, 7
    s_mov_b32 s39, 0
    s_mul_i32 s42, s3, 8320
    s_add_u32 s42, s42, 74240
    v_lshrrev_b32 v6, 2, v1
    v_and_b32 v5, 3, v6
    v_xor_b32 v5, s3, v5
    v_lshlrev_b32 v6, 8, v6
    v_lshl_add_u32 v6, v5, 6, v6
    v_and_b32_e64 v5, 3, v1
    v_lshl_add_u32 v6, v5, 4, v6
    s_lshl_b32 s34, s3, 5
    s_add_u32 s34, s34, 74240
    v_min_u32 v4, 2, v3
    v_mul_u32_u24 v5, 144, v2
    v_lshl_add_u32 v4, v4, 4, v5
    v_add_u32 v4, s34, v4
L_p2common:
    v_lshlrev_b32 v5, 4, v1
    v_add_u32 v5, 111104, v5
    v_lshlrev_b32 v160, s38, v2
    v_lshlrev_b32 v161, 3, v3
    v_sub_u32 v160, v160, v161
    v_add_u32 v160, s40, v160
    v_add_u32_e64 v161, s39, v160
    v_mov_b32 v164, 0x3500
    v_and_b32 v162, 1, v160
    v_lshlrev_b32 v162, 4, v162
    v_lshlrev_b32 v162, v162, v164
    v_ashrrev_i32 v163, 1, v160
    v_cmp_eq_u32 vcc, 0, v163
    s_nop 1
    v_cndmask_b32 v176, 0, v162, vcc
    v_cmp_eq_u32 vcc, 1, v163
    s_nop 1
    v_cndmask_b32 v177, 0, v162, vcc
    v_cmp_eq_u32 vcc, 2, v163
    s_nop 1
    v_cndmask_b32 v178, 0, v162, vcc
    v_cmp_eq_u32 vcc, 3, v163
    s_nop 1
    v_cndmask_b32 v179, 0, v162, vcc
    v_and_b32 v162, 1, v161
    v_lshlrev_b32 v162, 4, v162
    v_lshlrev_b32 v162, v162, v164
    v_ashrrev_i32 v163, 1, v161
    v_cmp_eq_u32 vcc, 0, v163
    s_nop 1
    v_cndmask_b32 v180, 0, v162, vcc
    v_cmp_eq_u32 vcc, 1, v163
    s_nop 1
    v_cndmask_b32 v181, 0, v162, vcc
    v_cmp_eq_u32 vcc, 2, v163
    s_nop 1
    v_cndmask_b32 v182, 0, v162, vcc
    v_cmp_eq_u32 vcc, 3, v163
    s_nop 1
    v_cndmask_b32 v183, 0, v162, vcc
    v_and_b32_e64 v7, 1, v3
    v_lshl_add_u32 v6, v7, 3, v6
    v_xor_b32_e64 v7, 8, v6
    v_bfe_u32 v8, v1, 1, 2
    v_xor_b32 v8, v8, v3
    v_lshlrev_b32 v8, 4, v8
    v_lshl_add_u32 v8, v2, 6, v8
    v_add_u32 v8, s42, v8
    v_mov_b32 v11, 1
    s_mov_b32 s34, 0x80008000
    s_mov_b32 s43, 0
    s_mov_b32 s46, 2.0
    s_mov_b32 s47, 2.0
    s_mov_b32 s33, 0x40000
L_fr:
    ds_read_b32 v15, v14 offset:12
    s_sub_u32 s33, s33, 1
    s_cbranch_scc1 L_fr_out
    s_waitcnt lgkmcnt(0)
    v_cmp_gt_u32 vcc, 4, v15
    s_nop 1
    s_and_b64 vcc, vcc, vcc
    s_cbranch_scc1 L_fr
L_fr_out:
    ds_read_b128 v[80:83], v5 offset:0
    ds_read_b128 v[84:87], v5 offset:1024
    ds_read_b128 v[88:91], v5 offset:2048
    ds_read_b128 v[92:95], v5 offset:3072
    ds_read_b128 v[96:99], v5 offset:4096
    ds_read_b128 v[100:103], v5 offset:5120
    ds_read_b128 v[104:107], v5 offset:6144
    ds_read_b128 v[108:111], v5 offset:7168
    ds_read_b128 v[112:115], v5 offset:8192
    ds_read_b128 v[116:119], v5 offset:9216
    ds_read_b128 v[120:123], v5 offset:10240
    ds_read_b128 v[124:127], v5 offset:11264
    ds_read_b128 v[128:131], v5 offset:12288
    ds_read_b128 v[132:135], v5 offset:13312
    ds_read_b128 v[136:139], v5 offset:14336
    ds_read_b128 v[140:143], v5 offset:15360
    s_waitcnt vmcnt(0)
    s_cmp_lt_u32 s3, 4
    s_cbranch_scc1 L_wreg
    s_mov_b32 s33, 0x8000
L_pollx:
    s_mov_b64 s[12:13], 0
    s_atomic_or_x2 s[12:13], s[24:25], s36 offset:1024 glc
    s_mov_b64 s[14:15], 0
    s_atomic_or_x2 s[14:15], s[24:25], s36 offset:1280 glc
    s_mov_b64 s[16:17], 0
    s_atomic_or_x2 s[16:17], s[24:25], s36 offset:1536 glc
    s_mov_b64 s[18:19], 0
    s_atomic_or_x2 s[18:19], s[24:25], s36 offset:1792 glc
    s_sub_u32 s33, s33, 1
    s_cbranch_scc1 L_pollx_out
    s_waitcnt lgkmcnt(0)
    s_cmp_lg_u32 s13, s51
    s_cbranch_scc1 L_pollx
    s_cmp_lg_u32 s15, s51
    s_cbranch_scc1 L_pollx
    s_cmp_lg_u32 s17, s51
    s_cbranch_scc1 L_pollx
    s_cmp_lg_u32 s19, s51
    s_cbranch_scc1 L_pollx
    s_and_b32 s12, s12, s14
    s_and_b32 s16, s16, s18
    s_and_b32 s12, s12, s16
    s_cmp_lg_u32 s12, 32
    s_cbranch_scc1 L_pollx
L_pollx_out:
    s_mov_b32 s36, s41
    buffer_load_dwordx4 v[192:195], v4, s[24:27], s36 offen offset:64 sc1
    buffer_load_dwordx4 v9, s[24:27], s36 offen sc1 lds
    s_add_u32 m0, m0, 4096
    s_add_u32 s36, s36, 2048
    buffer_load_dwordx4 v[196:199], v4, s[24:27], s36 offen offset:64 sc1
    buffer_load_dwordx4 v9, s[24:27], s36 offen sc1 lds
    s_add_u32 m0, m0, 4096
    s_add_u32 s36, s36, 2048
    buffer_load_dwordx4 v[200:203], v4, s[24:27], s36 offen offset:64 sc1
    buffer_load_dwordx4 v9, s[24:27], s36 offen sc1 lds
    s_add_u32 m0, m0, 4096
    s_add_u32 s36, s36, 2048
    buffer_load_dwordx4 v[204:207], v4, s[24:27], s36 offen offset:64 sc1
    buffer_load_dwordx4 v9, s[24:27], s36 offen sc1 lds
    s_add_u32 m0, m0, 4096
    s_add_u32 s36, s36, 2048
    buffer_load_dwordx4 v[208:211], v4, s[24:27], s36 offen offset:64 sc1
    buffer_load_dwordx4 v9, s[24:27], s36 offen sc1 lds
    s_add_u32 m0, m0, 4096
    s_add_u32 s36, s36, 2048
    buffer_load_dwordx4 v[212:215], v4, s[24:27], s36 offen offset:64 sc1
    buffer_load_dwordx4 v9, s[24:27], s36 offen sc1 lds
    s_add_u32 m0, m0, 4096
    s_add_u32 s36, s36, 2048
    buffer_load_dwordx4 v[216:219], v4, s[24:27], s36 offen offset:64 sc1
    buffer_load_dwordx4 v9, s[24:27], s36 offen sc1 lds
    s_add_u32 m0, m0, 4096
    s_add_u32 s36, s36, 2048
    buffer_load_dwordx4 v[220:223], v4, s[24:27], s36 offen offset:64 sc1
    buffer_load_dwordx4 v9, s[24:27], s36 offen sc1 lds
    s_setprio 0
    s_waitcnt vmcnt(14)
    v_mfma_f32_16x16x32_bf16 v[16:19], v[192:195], v[176:179], 0
    v_mfma_f32_16x16x32_bf16 v[48:51], v[192:195], v[180:183], 0
    s_nop 0
    s_waitcnt vmcnt(12)
    v_mfma_f32_16x16x32_bf16 v[20:23], v[196:199], v[176:179], 0
    v_mfma_f32_16x16x32_bf16 v[52:55], v[196:199], v[180:183], 0
    s_nop 0
    s_waitcnt vmcnt(10)
    v_mfma_f32_16x16x32_bf16 v[24:27], v[200:203], v[176:179], 0
    v_mfma_f32_16x16x32_bf16 v[56:59], v[200:203], v[180:183], 0
    s_nop 0
    s_waitcnt vmcnt(8)
    v_mfma_f32_16x16x32_bf16 v[28:31], v[204:207], v[176:179], 0
    v_mfma_f32_16x16x32_bf16 v[60:63], v[204:207], v[180:183], 0
    s_nop 0
    s_waitcnt vmcnt(6)
    v_mfma_f32_16x16x32_bf16 v[32:35], v[208:211], v[176:179], 0
    v_mfma_f32_16x16x32_bf16 v[64:67], v[208:211], v[180:183], 0
    s_nop 0
    s_waitcnt vmcnt(4)
    v_mfma_f32_16x16x32_bf16 v[36:39], v[212:215], v[176:179], 0
    v_mfma_f32_16x16x32_bf16 v[68:71], v[212:215], v[180:183], 0
    s_nop 0
    s_waitcnt vmcnt(2)
    v_mfma_f32_16x16x32_bf16 v[40:43], v[216:219], v[176:179], 0
    v_mfma_f32_16x16x32_bf16 v[72:75], v[216:219], v[180:183], 0
    s_nop 0
    s_waitcnt vmcnt(0)
    v_mfma_f32_16x16x32_bf16 v[44:47], v[220:223], v[176:179], 0
    v_mfma_f32_16x16x32_bf16 v[76:79], v[220:223], v[180:183], 0
    s_waitcnt lgkmcnt(0)
    s_branch L_f0
L_wreg:
    v_mov_b32 v15, 1
    s_mov_b64 exec, 1
    ds_add_u32 v14, v15 offset:0
    s_mov_b64 exec, -1
    s_mov_b32 s33, 0x40000
L_wr:
    ds_read_b32 v15, v14 offset:0
    s_sub_u32 s33, s33, 1
    s_cbranch_scc1 L_wr_out
    s_waitcnt lgkmcnt(0)
    v_cmp_gt_u32 vcc, 8, v15
    s_nop 1
    s_and_b64 vcc, vcc, vcc
    s_cbranch_scc1 L_wr
L_wr_out:
    ds_read_b128 v[192:195], v4 offset:0
    ds_read_b128 v[196:199], v4 offset:2304
    ds_read_b128 v[200:203], v4 offset:4608
    ds_read_b128 v[204:207], v4 offset:6912
    ds_read_b128 v[208:211], v4 offset:9216
    ds_read_b128 v[212:215], v4 offset:11520
    ds_read_b128 v[216:219], v4 offset:13824
    ds_read_b128 v[220:223], v4 offset:16128
    ds_read_b128 v[224:227], v4 offset:18432
    ds_read_b128 v[228:231], v4 offset:20736
    ds_read_b128 v[232:235], v4 offset:23040
    ds_read_b128 v[236:239], v4 offset:25344
    s_nop 0
    s_waitcnt lgkmcnt(8)
    ds_read_b128 v[240:243], v4 offset:27648
    ds_read_b128 v[244:247], v4 offset:29952
    ds_read_b128 v[248:251], v4 offset:32256
    ds_read_b128 v[252:255], v4 offset:34560
    v_mov_b32 v15, 0x100
    s_mov_b64 exec, 1
    ds_add_u32 v14, v15 offset:8
    s_mov_b64 exec, -1
    v_mfma_f32_16x16x32_bf16 v[16:19], v[192:195], v[176:179], 0
    v_mfma_f32_16x16x32_bf16 v[20:23], v[196:199], v[176:179], 0
    v_mfma_f32_16x16x32_bf16 v[24:27], v[200:203], v[176:179], 0
    v_mfma_f32_16x16x32_bf16 v[28:31], v[204:207], v[176:179], 0
    s_waitcnt lgkmcnt(12)
    v_mfma_f32_16x16x32_bf16 v[32:35], v[208:211], v[176:179], 0
    s_waitcnt lgkmcnt(11)
    v_mfma_f32_16x16x32_bf16 v[36:39], v[212:215], v[176:179], 0
    s_waitcnt lgkmcnt(10)
    v_mfma_f32_16x16x32_bf16 v[40:43], v[216:219], v[176:179], 0
    s_waitcnt lgkmcnt(9)
    v_mfma_f32_16x16x32_bf16 v[44:47], v[220:223], v[176:179], 0
    s_waitcnt lgkmcnt(8)
    v_mfma_f32_16x16x32_bf16 v[48:51], v[224:227], v[176:179], 0
    s_waitcnt lgkmcnt(7)
    v_mfma_f32_16x16x32_bf16 v[52:55], v[228:231], v[176:179], 0
    s_waitcnt lgkmcnt(6)
    v_mfma_f32_16x16x32_bf16 v[56:59], v[232:235], v[176:179], 0
    s_waitcnt lgkmcnt(5)
    v_mfma_f32_16x16x32_bf16 v[60:63], v[236:239], v[176:179], 0
    s_waitcnt lgkmcnt(4)
    v_mfma_f32_16x16x32_bf16 v[64:67], v[240:243], v[176:179], 0
    s_waitcnt lgkmcnt(3)
    v_mfma_f32_16x16x32_bf16 v[68:71], v[244:247], v[176:179], 0
    s_waitcnt lgkmcnt(2)
    v_mfma_f32_16x16x32_bf16 v[72:75], v[248:251], v[176:179], 0
    s_waitcnt lgkmcnt(1)
    v_mfma_f32_16x16x32_bf16 v[76:79], v[252:255], v[176:179], 0
    s_mov_b32 s33, 0x40000
L_go:
    ds_read_b32 v15, v14 offset:8
    s_sub_u32 s33, s33, 1
    s_cbranch_scc1 L_go_out
    s_waitcnt lgkmcnt(0)
    v_cmp_ne_u32 vcc, 1058, v15
    s_nop 1
    s_and_b64 vcc, vcc, vcc
    s_cbranch_scc1 L_go
L_go_out:
L_f0:
    ds_read_b64_tr_b16 v[144:145], v6 offset:0
    ds_read_b64_tr_b16 v[146:147], v6 offset:4096
    ds_read_b64_tr_b16 v[160:161], v7 offset:0
    ds_read_b64_tr_b16 v[162:163], v7 offset:4096
    ds_read_b64_tr_b16 v[148:149], v6 offset:8192
    ds_read_b64_tr_b16 v[150:151], v6 offset:12288
    ds_read_b64_tr_b16 v[164:165], v7 offset:8192
    ds_read_b64_tr_b16 v[166:167], v7 offset:12288
    ds_read_b64_tr_b16 v[152:153], v6 offset:16384
    ds_read_b64_tr_b16 v[154:155], v6 offset:20480
    ds_read_b64_tr_b16 v[168:169], v7 offset:16384
    ds_read_b64_tr_b16 v[170:171], v7 offset:20480
    s_waitcnt lgkmcnt(10)
    v_mfma_f32_16x16x32_bf16 v[192:195], v[80:83], v[144:147], 0
    v_xor_b32 v176, s34, v144
    v_xor_b32_e64 v177, s34, v145
    v_mfma_f32_16x16x32_bf16 v[196:199], v[88:91], v[144:147], 0
    v_xor_b32 v178, s34, v146
    v_xor_b32_e64 v179, s34, v147
    s_waitcnt lgkmcnt(8)
    v_mfma_f32_16x16x32_bf16 v[224:227], v[80:83], v[160:163], 0
    ds_read_b64_tr_b16 v[156:157], v6 offset:24576
    v_mfma_f32_16x16x32_bf16 v[228:231], v[88:91], v[160:163], 0
    ds_read_b64_tr_b16 v[158:159], v6 offset:28672
    v_mfma_f32_16x16x32_bf16 v[192:195], v[84:87], v[160:163], v[192:195]
    ds_read_b64_tr_b16 v[172:173], v7 offset:24576
    v_mfma_f32_16x16x32_bf16 v[196:199], v[92:95], v[160:163], v[196:199]
    ds_read_b64_tr_b16 v[174:175], v7 offset:28672
    v_mfma_f32_16x16x32_bf16 v[224:227], v[84:87], v[176:179], v[224:227]
    v_mfma_f32_16x16x32_bf16 v[228:231], v[92:95], v[176:179], v[228:231]
    s_waitcnt lgkmcnt(8)
    v_mfma_f32_16x16x32_bf16 v[200:203], v[96:99], v[148:151], 0
    v_xor_b32 v180, s34, v148
    v_xor_b32_e64 v181, s34, v149
    v_mfma_f32_16x16x32_bf16 v[204:207], v[104:107], v[148:151], 0
    v_xor_b32 v182, s34, v150
    v_xor_b32 v183, s34, v151
    v_mfma_f32_16x16x32_bf16 v[232:235], v[96:99], v[164:167], 0
    v_mfma_f32_16x16x32_bf16 v[236:239], v[104:107], v[164:167], 0
    v_mfma_f32_16x16x32_bf16 v[200:203], v[100:103], v[164:167], v[200:203]
    v_mfma_f32_16x16x32_bf16 v[204:207], v[108:111], v[164:167], v[204:207]
    v_mfma_f32_16x16x32_bf16 v[232:235], v[100:103], v[180:183], v[232:235]
    v_mfma_f32_16x16x32_bf16 v[236:239], v[108:111], v[180:183], v[236:239]
    s_waitcnt lgkmcnt(0)
    v_mfma_f32_16x16x32_bf16 v[208:211], v[112:115], v[152:155], v[192:195]
    v_xor_b32 v184, s34, v152
    v_xor_b32_e64 v185, s34, v153
    v_mfma_f32_16x16x32_bf16 v[212:215], v[120:123], v[152:155], v[196:199]
    v_xor_b32 v186, s34, v154
    v_xor_b32 v187, s34, v155
    v_mfma_f32_16x16x32_bf16 v[240:243], v[112:115], v[168:171], v[224:227]
    ds_read_b128 v[80:83], v5 offset:16384
    v_mfma_f32_16x16x32_bf16 v[244:247], v[120:123], v[168:171], v[228:231]
    ds_read_b128 v[84:87], v5 offset:17408
    v_mfma_f32_16x16x32_bf16 v[208:211], v[116:119], v[168:171], v[208:211]
    ds_read_b128 v[88:91], v5 offset:18432
    v_mfma_f32_16x16x32_bf16 v[212:215], v[124:127], v[168:171], v[212:215]
    ds_read_b128 v[92:95], v5 offset:19456
    v_mfma_f32_16x16x32_bf16 v[240:243], v[116:119], v[184:187], v[240:243]
    ds_read_b128 v[96:99], v5 offset:20480
    v_mfma_f32_16x16x32_bf16 v[244:247], v[124:127], v[184:187], v[244:247]
    ds_read_b128 v[100:103], v5 offset:21504
    v_mfma_f32_16x16x32_bf16 v[216:219], v[128:131], v[156:159], v[200:203]
    v_xor_b32 v188, s34, v156
    v_xor_b32 v189, s34, v157
    v_mfma_f32_16x16x32_bf16 v[220:223], v[136:139], v[156:159], v[204:207]
    v_xor_b32 v190, s34, v158
    v_xor_b32 v191, s34, v159
    v_mfma_f32_16x16x32_bf16 v[248:251], v[128:131], v[172:175], v[232:235]
    ds_read_b128 v[104:107], v5 offset:22528
    v_mfma_f32_16x16x32_bf16 v[252:255], v[136:139], v[172:175], v[236:239]
    ds_read_b128 v[108:111], v5 offset:23552
    v_mfma_f32_16x16x32_bf16 v[216:219], v[132:135], v[172:175], v[216:219]
    ds_read_b128 v[112:115], v5 offset:24576
    v_mfma_f32_16x16x32_bf16 v[220:223], v[140:143], v[172:175], v[220:223]
    ds_read_b128 v[116:119], v5 offset:25600
    v_mfma_f32_16x16x32_bf16 v[248:251], v[132:135], v[188:191], v[248:251]
    ds_read_b128 v[120:123], v5 offset:26624
    v_mfma_f32_16x16x32_bf16 v[252:255], v[140:143], v[188:191], v[252:255]
    ds_read_b128 v[124:127], v5 offset:27648
    ds_read_b128 v[128:131], v5 offset:28672
    ds_read_b128 v[132:135], v5 offset:29696
    ds_read_b128 v[136:139], v5 offset:30720
    ds_read_b128 v[140:143], v5 offset:31744
    s_nop 1
L_fwd_done:
    s_nop 1
    v_pk_fma_f32 v[180:181], v[192:193], s[46:47], v[208:209] neg_lo:[0,0,1] neg_hi:[0,0,1]
    v_pk_fma_f32 v[182:183], v[224:225], s[46:47], v[240:241] neg_lo:[0,0,1] neg_hi:[0,0,1]
    v_pk_fma_f32 v[188:189], v[200:201], s[46:47], v[216:217] neg_lo:[0,0,1] neg_hi:[0,0,1]
    v_pk_fma_f32 v[190:191], v[232:233], s[46:47], v[248:249] neg_lo:[0,0,1] neg_hi:[0,0,1]
    v_pk_add_f32 v[192:193], v[208:209], v[216:217]
    v_pk_add_f32 v[224:225], v[240:241], v[248:249]
    v_pk_add_f32 v[208:209], v[208:209], v[216:217] neg_lo:[0,1] neg_hi:[0,1]
    v_pk_add_f32 v[240:241], v[240:241], v[248:249] neg_lo:[0,1] neg_hi:[0,1]
    v_pk_add_f32 v[200:201], v[180:181], v[190:191]
    v_pk_add_f32 v[232:233], v[182:183], v[188:189] neg_lo:[0,1] neg_hi:[0,1]
    v_pk_add_f32 v[216:217], v[180:181], v[190:191] neg_lo:[0,1] neg_hi:[0,1]
    v_pk_add_f32 v[248:249], v[182:183], v[188:189]
    v_pk_mul_f32 v[176:177], v[192:193], v[16:17]
    v_pk_mul_f32 v[178:179], v[192:193], v[48:49]
    v_pk_mul_f32 v[180:181], v[200:201], v[24:25]
    v_pk_mul_f32 v[182:183], v[200:201], v[56:57]
    v_pk_mul_f32 v[184:185], v[208:209], v[32:33]
    v_pk_mul_f32 v[186:187], v[208:209], v[64:65]
    v_pk_mul_f32 v[188:189], v[216:217], v[40:41]
    v_pk_mul_f32 v[190:191], v[216:217], v[72:73]
    v_pk_fma_f32 v[176:177], v[224:225], v[48:49], v[176:177] neg_lo:[1,0,0] neg_hi:[1,0,0]
    v_pk_fma_f32 v[178:179], v[224:225], v[16:17], v[178:179]
    v_pk_fma_f32 v[180:181], v[232:233], v[56:57], v[180:181] neg_lo:[1,0,0] neg_hi:[1,0,0]
    v_pk_fma_f32 v[182:183], v[232:233], v[24:25], v[182:183]
    v_pk_fma_f32 v[184:185], v[240:241], v[64:65], v[184:185] neg_lo:[1,0,0] neg_hi:[1,0,0]
    v_pk_fma_f32 v[186:187], v[240:241], v[32:33], v[186:187]
    v_pk_fma_f32 v[188:189], v[248:249], v[72:73], v[188:189] neg_lo:[1,0,0] neg_hi:[1,0,0]
    v_pk_fma_f32 v[190:191], v[248:249], v[40:41], v[190:191]
    v_pk_add_f32 v[16:17], v[176:177], v[184:185]
    v_pk_add_f32 v[48:49], v[178:179], v[186:187]
    v_pk_add_f32 v[24:25], v[176:177], v[184:185] neg_lo:[0,1] neg_hi:[0,1]
    v_pk_add_f32 v[56:57], v[178:179], v[186:187] neg_lo:[0,1] neg_hi:[0,1]
    v_pk_add_f32 v[32:33], v[180:181], v[188:189]
    v_pk_add_f32 v[64:65], v[182:183], v[190:191]
    v_pk_add_f32 v[40:41], v[180:181], v[188:189] neg_lo:[0,1] neg_hi:[0,1]
    v_pk_add_f32 v[72:73], v[182:183], v[190:191] neg_lo:[0,1] neg_hi:[0,1]
    v_pk_add_f32 v[192:193], v[16:17], v[32:33]
    v_pk_add_f32 v[224:225], v[48:49], v[64:65]
    v_pk_add_f32 v[208:209], v[16:17], v[32:33] neg_lo:[0,1] neg_hi:[0,1]
    v_pk_add_f32 v[240:241], v[48:49], v[64:65] neg_lo:[0,1] neg_hi:[0,1]
    v_pk_add_f32 v[200:201], v[24:25], v[72:73] neg_lo:[0,1] neg_hi:[0,1]
    v_pk_add_f32 v[232:233], v[56:57], v[40:41]
    v_pk_add_f32 v[216:217], v[24:25], v[72:73]
    v_pk_add_f32 v[248:249], v[56:57], v[40:41] neg_lo:[0,1] neg_hi:[0,1]
    v_pk_fma_f32 v[180:181], v[194:195], s[46:47], v[210:211] neg_lo:[0,0,1] neg_hi:[0,0,1]
    v_pk_fma_f32 v[182:183], v[226:227], s[46:47], v[242:243] neg_lo:[0,0,1] neg_hi:[0,0,1]
    v_pk_fma_f32 v[188:189], v[202:203], s[46:47], v[218:219] neg_lo:[0,0,1] neg_hi:[0,0,1]
    v_pk_fma_f32 v[190:191], v[234:235], s[46:47], v[250:251] neg_lo:[0,0,1] neg_hi:[0,0,1]
    v_pk_add_f32 v[194:195], v[210:211], v[218:219]
    v_pk_add_f32 v[226:227], v[242:243], v[250:251]
    v_pk_add_f32 v[210:211], v[210:211], v[218:219] neg_lo:[0,1] neg_hi:[0,1]
    v_pk_add_f32 v[242:243], v[242:243], v[250:251] neg_lo:[0,1] neg_hi:[0,1]
    v_pk_add_f32 v[202:203], v[180:181], v[190:191]
    v_pk_add_f32 v[234:235], v[182:183], v[188:189] neg_lo:[0,1] neg_hi:[0,1]
    v_pk_add_f32 v[218:219], v[180:181], v[190:191] neg_lo:[0,1] neg_hi:[0,1]
    v_pk_add_f32 v[250:251], v[182:183], v[188:189]
    v_pk_mul_f32 v[176:177], v[194:195], v[18:19]
    v_pk_mul_f32 v[178:179], v[194:195], v[50:51]
    v_pk_mul_f32 v[180:181], v[202:203], v[26:27]
    v_pk_mul_f32 v[182:183], v[202:203], v[58:59]
    v_pk_mul_f32 v[184:185], v[210:211], v[34:35]
    v_pk_mul_f32 v[186:187], v[210:211], v[66:67]
    v_pk_mul_f32 v[188:189], v[218:219], v[42:43]
    v_pk_mul_f32 v[190:191], v[218:219], v[74:75]
    v_pk_fma_f32 v[176:177], v[226:227], v[50:51], v[176:177] neg_lo:[1,0,0] neg_hi:[1,0,0]
    v_pk_fma_f32 v[178:179], v[226:227], v[18:19], v[178:179]
    v_pk_fma_f32 v[180:181], v[234:235], v[58:59], v[180:181] neg_lo:[1,0,0] neg_hi:[1,0,0]
    v_pk_fma_f32 v[182:183], v[234:235], v[26:27], v[182:183]
    v_pk_fma_f32 v[184:185], v[242:243], v[66:67], v[184:185] neg_lo:[1,0,0] neg_hi:[1,0,0]
    v_pk_fma_f32 v[186:187], v[242:243], v[34:35], v[186:187]
    v_pk_fma_f32 v[188:189], v[250:251], v[74:75], v[188:189] neg_lo:[1,0,0] neg_hi:[1,0,0]
    v_pk_fma_f32 v[190:191], v[250:251], v[42:43], v[190:191]
    v_pk_add_f32 v[18:19], v[176:177], v[184:185]
    v_pk_add_f32 v[50:51], v[178:179], v[186:187]
    v_pk_add_f32 v[26:27], v[176:177], v[184:185] neg_lo:[0,1] neg_hi:[0,1]
    v_pk_add_f32 v[58:59], v[178:179], v[186:187] neg_lo:[0,1] neg_hi:[0,1]
    v_pk_add_f32 v[34:35], v[180:181], v[188:189]
    v_pk_add_f32 v[66:67], v[182:183], v[190:191]
    v_pk_add_f32 v[42:43], v[180:181], v[188:189] neg_lo:[0,1] neg_hi:[0,1]
    v_pk_add_f32 v[74:75], v[182:183], v[190:191] neg_lo:[0,1] neg_hi:[0,1]
    v_pk_add_f32 v[194:195], v[18:19], v[34:35]
    v_pk_add_f32 v[226:227], v[50:51], v[66:67]
    v_pk_add_f32 v[210:211], v[18:19], v[34:35] neg_lo:[0,1] neg_hi:[0,1]
    v_pk_add_f32 v[242:243], v[50:51], v[66:67] neg_lo:[0,1] neg_hi:[0,1]
    v_pk_add_f32 v[202:203], v[26:27], v[74:75] neg_lo:[0,1] neg_hi:[0,1]
    v_pk_add_f32 v[234:235], v[58:59], v[42:43]
    v_pk_add_f32 v[218:219], v[26:27], v[74:75]
    v_pk_add_f32 v[250:251], v[58:59], v[42:43] neg_lo:[0,1] neg_hi:[0,1]
    v_pk_fma_f32 v[180:181], v[196:197], s[46:47], v[212:213] neg_lo:[0,0,1] neg_hi:[0,0,1]
    v_pk_fma_f32 v[182:183], v[228:229], s[46:47], v[244:245] neg_lo:[0,0,1] neg_hi:[0,0,1]
    v_pk_fma_f32 v[188:189], v[204:205], s[46:47], v[220:221] neg_lo:[0,0,1] neg_hi:[0,0,1]
    v_pk_fma_f32 v[190:191], v[236:237], s[46:47], v[252:253] neg_lo:[0,0,1] neg_hi:[0,0,1]
    v_pk_add_f32 v[196:197], v[212:213], v[220:221]
    v_pk_add_f32 v[228:229], v[244:245], v[252:253]
    v_pk_add_f32 v[212:213], v[212:213], v[220:221] neg_lo:[0,1] neg_hi:[0,1]
    v_pk_add_f32 v[244:245], v[244:245], v[252:253] neg_lo:[0,1] neg_hi:[0,1]
    v_pk_add_f32 v[204:205], v[180:181], v[190:191]
    v_pk_add_f32 v[236:237], v[182:183], v[188:189] neg_lo:[0,1] neg_hi:[0,1]
    v_pk_add_f32 v[220:221], v[180:181], v[190:191] neg_lo:[0,1] neg_hi:[0,1]
    v_pk_add_f32 v[252:253], v[182:183], v[188:189]
    v_pk_mul_f32 v[176:177], v[196:197], v[20:21]
    v_pk_mul_f32 v[178:179], v[196:197], v[52:53]
    v_pk_mul_f32 v[180:181], v[204:205], v[28:29]
    v_pk_mul_f32 v[182:183], v[204:205], v[60:61]
    v_pk_mul_f32 v[184:185], v[212:213], v[36:37]
    v_pk_mul_f32 v[186:187], v[212:213], v[68:69]
    v_pk_mul_f32 v[188:189], v[220:221], v[44:45]
    v_pk_mul_f32 v[190:191], v[220:221], v[76:77]
    v_pk_fma_f32 v[176:177], v[228:229], v[52:53], v[176:177] neg_lo:[1,0,0] neg_hi:[1,0,0]
    v_pk_fma_f32 v[178:179], v[228:229], v[20:21], v[178:179]
    v_pk_fma_f32 v[180:181], v[236:237], v[60:61], v[180:181] neg_lo:[1,0,0] neg_hi:[1,0,0]
    v_pk_fma_f32 v[182:183], v[236:237], v[28:29], v[182:183]
    v_pk_fma_f32 v[184:185], v[244:245], v[68:69], v[184:185] neg_lo:[1,0,0] neg_hi:[1,0,0]
    v_pk_fma_f32 v[186:187], v[244:245], v[36:37], v[186:187]
    v_pk_fma_f32 v[188:189], v[252:253], v[76:77], v[188:189] neg_lo:[1,0,0] neg_hi:[1,0,0]
    v_pk_fma_f32 v[190:191], v[252:253], v[44:45], v[190:191]
    v_pk_add_f32 v[20:21], v[176:177], v[184:185]
    v_pk_add_f32 v[52:53], v[178:179], v[186:187]
    v_pk_add_f32 v[28:29], v[176:177], v[184:185] neg_lo:[0,1] neg_hi:[0,1]
    v_pk_add_f32 v[60:61], v[178:179], v[186:187] neg_lo:[0,1] neg_hi:[0,1]
    v_pk_add_f32 v[36:37], v[180:181], v[188:189]
    v_pk_add_f32 v[68:69], v[182:183], v[190:191]
    v_pk_add_f32 v[44:45], v[180:181], v[188:189] neg_lo:[0,1] neg_hi:[0,1]
    v_pk_add_f32 v[76:77], v[182:183], v[190:191] neg_lo:[0,1] neg_hi:[0,1]
    v_pk_add_f32 v[196:197], v[20:21], v[36:37]
    v_pk_add_f32 v[228:229], v[52:53], v[68:69]
    v_pk_add_f32 v[212:213], v[20:21], v[36:37] neg_lo:[0,1] neg_hi:[0,1]
    v_pk_add_f32 v[244:245], v[52:53], v[68:69] neg_lo:[0,1] neg_hi:[0,1]
    v_pk_add_f32 v[204:205], v[28:29], v[76:77] neg_lo:[0,1] neg_hi:[0,1]
    v_pk_add_f32 v[236:237], v[60:61], v[44:45]
    v_pk_add_f32 v[220:221], v[28:29], v[76:77]
    v_pk_add_f32 v[252:253], v[60:61], v[44:45] neg_lo:[0,1] neg_hi:[0,1]
    v_pk_fma_f32 v[180:181], v[198:199], s[46:47], v[214:215] neg_lo:[0,0,1] neg_hi:[0,0,1]
    v_pk_fma_f32 v[182:183], v[230:231], s[46:47], v[246:247] neg_lo:[0,0,1] neg_hi:[0,0,1]
    v_pk_fma_f32 v[188:189], v[206:207], s[46:47], v[222:223] neg_lo:[0,0,1] neg_hi:[0,0,1]
    v_pk_fma_f32 v[190:191], v[238:239], s[46:47], v[254:255] neg_lo:[0,0,1] neg_hi:[0,0,1]
    v_pk_add_f32 v[198:199], v[214:215], v[222:223]
    v_pk_add_f32 v[230:231], v[246:247], v[254:255]
    v_pk_add_f32 v[214:215], v[214:215], v[222:223] neg_lo:[0,1] neg_hi:[0,1]
    v_pk_add_f32 v[246:247], v[246:247], v[254:255] neg_lo:[0,1] neg_hi:[0,1]
    v_pk_add_f32 v[206:207], v[180:181], v[190:191]
    v_pk_add_f32 v[238:239], v[182:183], v[188:189] neg_lo:[0,1] neg_hi:[0,1]
    v_pk_add_f32 v[222:223], v[180:181], v[190:191] neg_lo:[0,1] neg_hi:[0,1]
    v_pk_add_f32 v[254:255], v[182:183], v[188:189]
    v_pk_mul_f32 v[176:177], v[198:199], v[22:23]
    v_pk_mul_f32 v[178:179], v[198:199], v[54:55]
    v_pk_mul_f32 v[180:181], v[206:207], v[30:31]
    v_pk_mul_f32 v[182:183], v[206:207], v[62:63]
    v_pk_mul_f32 v[184:185], v[214:215], v[38:39]
    v_pk_mul_f32 v[186:187], v[214:215], v[70:71]
    v_pk_mul_f32 v[188:189], v[222:223], v[46:47]
    v_pk_mul_f32 v[190:191], v[222:223], v[78:79]
    v_pk_fma_f32 v[176:177], v[230:231], v[54:55], v[176:177] neg_lo:[1,0,0] neg_hi:[1,0,0]
    v_pk_fma_f32 v[178:179], v[230:231], v[22:23], v[178:179]
    v_pk_fma_f32 v[180:181], v[238:239], v[62:63], v[180:181] neg_lo:[1,0,0] neg_hi:[1,0,0]
    v_pk_fma_f32 v[182:183], v[238:239], v[30:31], v[182:183]
    v_pk_fma_f32 v[184:185], v[246:247], v[70:71], v[184:185] neg_lo:[1,0,0] neg_hi:[1,0,0]
    v_pk_fma_f32 v[186:187], v[246:247], v[38:39], v[186:187]
    v_pk_fma_f32 v[188:189], v[254:255], v[78:79], v[188:189] neg_lo:[1,0,0] neg_hi:[1,0,0]
    v_pk_fma_f32 v[190:191], v[254:255], v[46:47], v[190:191]
    v_pk_add_f32 v[22:23], v[176:177], v[184:185]
    v_pk_add_f32 v[54:55], v[178:179], v[186:187]
    v_pk_add_f32 v[30:31], v[176:177], v[184:185] neg_lo:[0,1] neg_hi:[0,1]
    v_pk_add_f32 v[62:63], v[178:179], v[186:187] neg_lo:[0,1] neg_hi:[0,1]
    v_pk_add_f32 v[38:39], v[180:181], v[188:189]
    v_pk_add_f32 v[70:71], v[182:183], v[190:191]
    v_pk_add_f32 v[46:47], v[180:181], v[188:189] neg_lo:[0,1] neg_hi:[0,1]
    v_pk_add_f32 v[78:79], v[182:183], v[190:191] neg_lo:[0,1] neg_hi:[0,1]
    v_pk_add_f32 v[198:199], v[22:23], v[38:39]
    v_pk_add_f32 v[230:231], v[54:55], v[70:71]
    v_pk_add_f32 v[214:215], v[22:23], v[38:39] neg_lo:[0,1] neg_hi:[0,1]
    v_pk_add_f32 v[246:247], v[54:55], v[70:71] neg_lo:[0,1] neg_hi:[0,1]
    v_pk_add_f32 v[206:207], v[30:31], v[78:79] neg_lo:[0,1] neg_hi:[0,1]
    v_pk_add_f32 v[238:239], v[62:63], v[46:47]
    v_pk_add_f32 v[222:223], v[30:31], v[78:79]
    v_pk_add_f32 v[254:255], v[62:63], v[46:47] neg_lo:[0,1] neg_hi:[0,1]
    v_cvt_pk_bf16_f32 v144, v192, v193
    v_cvt_pk_bf16_f32 v145, v194, v195
    v_cvt_pk_bf16_f32 v146, v196, v197
    v_cvt_pk_bf16_f32 v147, v198, v199
    v_cvt_pk_bf16_f32 v160, v224, v225
    v_cvt_pk_bf16_f32 v161, v226, v227
    v_cvt_pk_bf16_f32 v162, v228, v229
    v_cvt_pk_bf16_f32 v163, v230, v231
    v_cvt_pk_bf16_f32 v176, -v224, -v225
    v_cvt_pk_bf16_f32 v177, -v226, -v227
    v_cvt_pk_bf16_f32 v178, -v228, -v229
    v_cvt_pk_bf16_f32 v179, -v230, -v231
    s_nop 0
    s_waitcnt lgkmcnt(0)
    v_mfma_f32_16x16x32_bf16 v[192:195], v[144:147], v[80:83], 0
    v_cvt_pk_bf16_f32 v148, v200, v201
    v_cvt_pk_bf16_f32 v149, v202, v203
    v_mfma_f32_16x16x32_bf16 v[224:227], v[160:163], v[80:83], 0
    v_cvt_pk_bf16_f32 v150, v204, v205
    v_cvt_pk_bf16_f32 v151, v206, v207
    v_mfma_f32_16x16x32_bf16 v[192:195], v[176:179], v[84:87], v[192:195]
    v_cvt_pk_bf16_f32 v164, v232, v233
    v_cvt_pk_bf16_f32 v165, v234, v235
    v_mfma_f32_16x16x32_bf16 v[224:227], v[144:147], v[84:87], v[224:227]
    v_mfma_f32_16x16x32_bf16 v[196:199], v[144:147], v[88:91], 0
    v_cvt_pk_bf16_f32 v166, v236, v237
    v_cvt_pk_bf16_f32 v167, v238, v239
    v_cvt_pk_bf16_f32 v180, -v232, -v233
    v_mfma_f32_16x16x32_bf16 v[228:231], v[160:163], v[88:91], 0
    v_cvt_pk_bf16_f32 v181, -v234, -v235
    v_cvt_pk_bf16_f32 v182, -v236, -v237
    v_cvt_pk_bf16_f32 v183, -v238, -v239
    v_mfma_f32_16x16x32_bf16 v[196:199], v[176:179], v[92:95], v[196:199]
    v_cvt_pk_bf16_f32 v16, v192, v193
    v_cvt_pk_bf16_f32 v17, v194, v195
    v_mfma_f32_16x16x32_bf16 v[228:231], v[144:147], v[92:95], v[228:231]
    v_cvt_pk_bf16_f32 v18, v224, v225
    v_cvt_pk_bf16_f32 v19, v226, v227
    ds_write_b128 v8, v[16:19] offset:0
    ds_add_u32 v13, v11
    v_mfma_f32_16x16x32_bf16 v[200:203], v[148:151], v[96:99], 0
    v_cvt_pk_bf16_f32 v152, v208, v209
    v_cvt_pk_bf16_f32 v153, v210, v211
    v_cvt_pk_bf16_f32 v154, v212, v213
    v_mfma_f32_16x16x32_bf16 v[232:235], v[164:167], v[96:99], 0
    v_cvt_pk_bf16_f32 v155, v214, v215
    v_cvt_pk_bf16_f32 v168, v240, v241
    v_cvt_pk_bf16_f32 v169, v242, v243
    v_mfma_f32_16x16x32_bf16 v[200:203], v[180:183], v[100:103], v[200:203]
    v_cvt_pk_bf16_f32 v20, v196, v197
    v_cvt_pk_bf16_f32 v21, v198, v199
    v_mfma_f32_16x16x32_bf16 v[232:235], v[148:151], v[100:103], v[232:235]
    v_cvt_pk_bf16_f32 v22, v228, v229
    v_cvt_pk_bf16_f32 v23, v230, v231
    ds_write_b128 v8, v[20:23] offset:1024
    ds_add_u32 v13, v11
    v_mfma_f32_16x16x32_bf16 v[204:207], v[148:151], v[104:107], 0
    v_cvt_pk_bf16_f32 v170, v244, v245
    v_cvt_pk_bf16_f32 v171, v246, v247
    v_cvt_pk_bf16_f32 v184, -v240, -v241
    v_mfma_f32_16x16x32_bf16 v[236:239], v[164:167], v[104:107], 0
    v_cvt_pk_bf16_f32 v185, -v242, -v243
    v_cvt_pk_bf16_f32 v186, -v244, -v245
    v_cvt_pk_bf16_f32 v187, -v246, -v247
    v_mfma_f32_16x16x32_bf16 v[204:207], v[180:183], v[108:111], v[204:207]
    v_cvt_pk_bf16_f32 v24, v200, v201
    v_cvt_pk_bf16_f32 v25, v202, v203
    v_mfma_f32_16x16x32_bf16 v[236:239], v[148:151], v[108:111], v[236:239]
    v_cvt_pk_bf16_f32 v26, v232, v233
    v_cvt_pk_bf16_f32 v27, v234, v235
    ds_write_b128 v8, v[24:27] offset:2048
    ds_add_u32 v13, v11
    v_mfma_f32_16x16x32_bf16 v[208:211], v[152:155], v[112:115], 0
    v_cvt_pk_bf16_f32 v156, v216, v217
    v_cvt_pk_bf16_f32 v157, v218, v219
    v_cvt_pk_bf16_f32 v158, v220, v221
    v_mfma_f32_16x16x32_bf16 v[240:243], v[168:171], v[112:115], 0
    v_cvt_pk_bf16_f32 v159, v222, v223
    v_cvt_pk_bf16_f32 v172, v248, v249
    v_cvt_pk_bf16_f32 v173, v250, v251
    v_mfma_f32_16x16x32_bf16 v[208:211], v[184:187], v[116:119], v[208:211]
    v_cvt_pk_bf16_f32 v28, v204, v205
    v_cvt_pk_bf16_f32 v29, v206, v207
    v_mfma_f32_16x16x32_bf16 v[240:243], v[152:155], v[116:119], v[240:243]
    v_cvt_pk_bf16_f32 v30, v236, v237
    v_cvt_pk_bf16_f32 v31, v238, v239
    ds_write_b128 v8, v[28:31] offset:3072
    ds_add_u32 v13, v11
    v_mfma_f32_16x16x32_bf16 v[212:215], v[152:155], v[120:123], 0
    v_cvt_pk_bf16_f32 v174, v252, v253
    v_cvt_pk_bf16_f32 v175, v254, v255
    v_cvt_pk_bf16_f32 v188, -v248, -v249
    v_mfma_f32_16x16x32_bf16 v[244:247], v[168:171], v[120:123], 0
    v_cvt_pk_bf16_f32 v189, -v250, -v251
    v_cvt_pk_bf16_f32 v190, -v252, -v253
    v_cvt_pk_bf16_f32 v191, -v254, -v255
    v_mfma_f32_16x16x32_bf16 v[212:215], v[184:187], v[124:127], v[212:215]
    v_cvt_pk_bf16_f32 v32, v208, v209
    v_cvt_pk_bf16_f32 v33, v210, v211
    v_mfma_f32_16x16x32_bf16 v[244:247], v[152:155], v[124:127], v[244:247]
    v_cvt_pk_bf16_f32 v34, v240, v241
    v_cvt_pk_bf16_f32 v35, v242, v243
    ds_write_b128 v8, v[32:35] offset:4096
    ds_add_u32 v13, v11
    v_mfma_f32_16x16x32_bf16 v[216:219], v[156:159], v[128:131], 0
    v_mfma_f32_16x16x32_bf16 v[248:251], v[172:175], v[128:131], 0
    v_mfma_f32_16x16x32_bf16 v[216:219], v[188:191], v[132:135], v[216:219]
    v_mfma_f32_16x16x32_bf16 v[248:251], v[156:159], v[132:135], v[248:251]
    v_cvt_pk_bf16_f32 v36, v212, v213
    v_cvt_pk_bf16_f32 v37, v214, v215
    v_cvt_pk_bf16_f32 v38, v244, v245
    v_cvt_pk_bf16_f32 v39, v246, v247
    ds_write_b128 v8, v[36:39] offset:5120
    ds_add_u32 v13, v11
    v_mfma_f32_16x16x32_bf16 v[220:223], v[156:159], v[136:139], 0
    v_mfma_f32_16x16x32_bf16 v[252:255], v[172:175], v[136:139], 0
    v_mfma_f32_16x16x32_bf16 v[220:223], v[188:191], v[140:143], v[220:223]
    v_mfma_f32_16x16x32_bf16 v[252:255], v[156:159], v[140:143], v[252:255]
    v_cvt_pk_bf16_f32 v40, v216, v217
    v_cvt_pk_bf16_f32 v41, v218, v219
    v_cvt_pk_bf16_f32 v42, v248, v249
    v_cvt_pk_bf16_f32 v43, v250, v251
    ds_write_b128 v8, v[40:43] offset:6144
    ds_add_u32 v13, v11
    s_nop 0
    s_nop 0
    v_cvt_pk_bf16_f32 v44, v220, v221
    v_cvt_pk_bf16_f32 v45, v222, v223
    v_cvt_pk_bf16_f32 v46, v252, v253
    v_cvt_pk_bf16_f32 v47, v254, v255
    ds_write_b128 v8, v[44:47] offset:7168
    ds_add_u32 v13, v11
    s_cmp_lt_u32 s3, 4
    s_cbranch_scc1 L_setup3
    v_lshlrev_b32_e64 v8, 7, v2
    v_lshl_add_u32 v8, v3, 4, v8
    v_mov_b32 v49, s51
    v_mov_b32 v51, s51
    v_mov_b32 v53, s51
    v_mov_b32 v55, s51
    v_mov_b32 v57, s51
    v_mov_b32 v59, s51
    v_mov_b32 v61, s51
    v_mov_b32 v63, s51
    v_cvt_pk_bf16_f32 v48, v192, v224
    v_cvt_pk_bf16_f32 v50, v193, v225
    v_cvt_pk_bf16_f32 v52, v194, v226
    v_cvt_pk_bf16_f32 v54, v195, v227
    buffer_store_dwordx4 v[48:51], v8, s[24:27], s41 offen offset:0 sc1
    buffer_store_dwordx4 v[52:55], v8, s[24:27], s41 offen offset:64 sc1
    v_cvt_pk_bf16_f32 v56, v196, v228
    v_cvt_pk_bf16_f32 v58, v197, v229
    v_cvt_pk_bf16_f32 v60, v198, v230
    v_cvt_pk_bf16_f32 v62, v199, v231
    buffer_store_dwordx4 v[56:59], v8, s[24:27], s41 offen offset:2048 sc1
    buffer_store_dwordx4 v[60:63], v8, s[24:27], s41 offen offset:2112 sc1
    s_add_u32 s41, s41, 4096
    v_cvt_pk_bf16_f32 v48, v200, v232
    v_cvt_pk_bf16_f32 v50, v201, v233
    v_cvt_pk_bf16_f32 v52, v202, v234
    v_cvt_pk_bf16_f32 v54, v203, v235
    buffer_store_dwordx4 v[48:51], v8, s[24:27], s41 offen offset:0 sc1
    buffer_store_dwordx4 v[52:55], v8, s[24:27], s41 offen offset:64 sc1
    v_cvt_pk_bf16_f32 v56, v204, v236
    v_cvt_pk_bf16_f32 v58, v205, v237
    v_cvt_pk_bf16_f32 v60, v206, v238
    v_cvt_pk_bf16_f32 v62, v207, v239
    buffer_store_dwordx4 v[56:59], v8, s[24:27], s41 offen offset:2048 sc1
    buffer_store_dwordx4 v[60:63], v8, s[24:27], s41 offen offset:2112 sc1
    s_add_u32 s41, s41, 4096
    v_cvt_pk_bf16_f32 v48, v208, v240
    v_cvt_pk_bf16_f32 v50, v209, v241
    v_cvt_pk_bf16_f32 v52, v210, v242
    v_cvt_pk_bf16_f32 v54, v211, v243
    buffer_store_dwordx4 v[48:51], v8, s[24:27], s41 offen offset:0 sc1
    buffer_store_dwordx4 v[52:55], v8, s[24:27], s41 offen offset:64 sc1
    v_cvt_pk_bf16_f32 v56, v212, v244
    v_cvt_pk_bf16_f32 v58, v213, v245
    v_cvt_pk_bf16_f32 v60, v214, v246
    v_cvt_pk_bf16_f32 v62, v215, v247
    buffer_store_dwordx4 v[56:59], v8, s[24:27], s41 offen offset:2048 sc1
    buffer_store_dwordx4 v[60:63], v8, s[24:27], s41 offen offset:2112 sc1
    s_add_u32 s41, s41, 4096
    v_cvt_pk_bf16_f32 v48, v216, v248
    v_cvt_pk_bf16_f32 v50, v217, v249
    v_cvt_pk_bf16_f32 v52, v218, v250
    v_cvt_pk_bf16_f32 v54, v219, v251
    buffer_store_dwordx4 v[48:51], v8, s[24:27], s41 offen offset:0 sc1
    buffer_store_dwordx4 v[52:55], v8, s[24:27], s41 offen offset:64 sc1
    v_cvt_pk_bf16_f32 v56, v220, v252
    v_cvt_pk_bf16_f32 v58, v221, v253
    v_cvt_pk_bf16_f32 v60, v222, v254
    v_cvt_pk_bf16_f32 v62, v223, v255
    buffer_store_dwordx4 v[56:59], v8, s[24:27], s41 offen offset:2048 sc1
    buffer_store_dwordx4 v[60:63], v8, s[24:27], s41 offen offset:2112 sc1
    s_add_u32 s41, s41, 4096
    s_setprio 0
    s_branch L_setup3
L_helper:
    v_mov_b32 v15, 1
    s_mov_b64 exec, 1
    ds_add_u32 v14, v15 offset:0
    s_mov_b64 exec, -1
    s_cmp_eq_u32 s2, 128
    s_cselect_b32 s37, s3, 0
    s_cmp_eq_u32 s2, 161
    s_cselect_b32 s37, s3, s37
    s_cmp_lg_u32 s37, 4
    s_cbranch_scc1 L_loader
    s_mov_b32 s38, 1
    s_mov_b32 s40, 0
    s_mov_b32 s39, 1
    s_cmp_eq_u32 s2, 161
    s_cselect_b32 s41, 0x4000, 0
    s_lshl1_add_u32 s36, s41, 65536
    s_add_u32 s41, s41, 196608
    v_lshrrev_b32 v9, 2, v1
    v_and_b32 v4, 3, v1
    v_lshlrev_b32_e64 v4, 4, v4
    v_lshl_add_u32 v9, v9, 7, v4
    v_lshlrev_b32_e64 v4, 7, v2
    v_lshl_add_u32 v4, v3, 4, v4
    s_mov_b32 s42, 66048
    v_lshlrev_b32_e64 v6, 4, v1
    v_add_u32 v6, 32768, v6
    s_mov_b32 m0, 32768
    s_branch L_p2common
L_loader:
    s_sub_u32 s35, s3, 4
    s_and_b32 s44, s7, 8
    s_add_u32 s44, s44, s32
    s_lshl_b32 s44, s44, 11
    s_add_u32 s44, s44, s53
    s_and_b32 s43, s7, 7
    s_add_u32 s44, s44, s43
    s_lshl_b32 s44, s44, 8
    s_lshl_b32 s38, s35, 12
    s_add_u32 s38, s38, s44
    s_lshl2_add_u32 s39, s32, s35
    s_mul_i32 s39, s39, 256
    s_add_u32 s39, s39, s30
    s_lshl_b32 m0, s35, 13
    s_xor_b32 s40, s38, 2162688
    v_lshlrev_b32 v9, 2, v3
    v_xor_b32 v9, v9, v2
    v_lshlrev_b32_e64 v9, 4, v9
    v_lshl_add_u32 v9, v3, 14, v9
    s_bitcmp1_b32 s3, 0
    s_cselect_b32 s41, 16, 1
    s_cmp_eq_u32 s37, 5
    s_cselect_b32 s41, 17, s41
    v_mov_b32_e64 v4, s41
    s_cbranch_scc0 L_single
    s_mov_b32 s50, 32
    s_mov_b32 s33, 0x8000
    s_sub_u32 s36, s39, 256
L_dual:
    s_mov_b64 s[12:13], 0
    s_atomic_or_x2 s[12:13], s[24:25], s36 glc
    s_mov_b64 s[48:49], 0
    s_atomic_or_x2 s[48:49], s[24:25], s39 glc
    s_sub_u32 s33, s33, 1
    s_cbranch_scc1 L_poll1_out
    s_waitcnt lgkmcnt(0)
    s_cmp_eq_u64 s[12:13], s[50:51]
    s_cbranch_scc0 L_dual
    s_cmp_eq_u64 s[48:49], s[50:51]
    s_cbranch_scc1 L_poll1_out
L_single:
    s_mov_b32 s50, 32
    s_mov_b32 s33, 0x8000
L_poll1:
    s_mov_b64 s[48:49], 0
    s_atomic_or_x2 s[48:49], s[24:25], s39 glc
    s_sub_u32 s33, s33, 1
    s_cbranch_scc1 L_poll1_out
    s_waitcnt lgkmcnt(0)
    s_cmp_eq_u64 s[48:49], s[50:51]
    s_cbranch_scc0 L_poll1
L_poll1_out:
    buffer_load_dwordx4 v9, s[20:23], s38 offen sc1 lds
    s_add_u32 m0, m0, 1024
    s_add_u32 s38, s38, 131072
    buffer_load_dwordx4 v9, s[20:23], s40 offen sc1 lds
    s_add_u32 m0, m0, 1024
    s_add_u32 s40, s40, 131072
    buffer_load_dwordx4 v9, s[20:23], s38 offen sc1 lds
    s_add_u32 m0, m0, 1024
    s_add_u32 s38, s38, 131072
    buffer_load_dwordx4 v9, s[20:23], s40 offen sc1 lds
    s_add_u32 m0, m0, 1024
    s_add_u32 s40, s40, 131072
    buffer_load_dwordx4 v9, s[20:23], s38 offen sc1 lds
    s_add_u32 m0, m0, 1024
    s_add_u32 s38, s38, 131072
    buffer_load_dwordx4 v9, s[20:23], s40 offen sc1 lds
    s_add_u32 m0, m0, 1024
    s_add_u32 s40, s40, 131072
    buffer_load_dwordx4 v9, s[20:23], s38 offen sc1 lds
    s_add_u32 m0, m0, 1024
    s_nop 0
    buffer_load_dwordx4 v9, s[20:23], s40 offen sc1 lds
    s_cmp_lg_u32 s37, 5
    s_cbranch_scc1 L_posted
    s_mov_b32 s37, 0
    s_mov_b32 m0, 0
    s_mov_b32 s38, s44
    s_xor_b32 s40, s38, 2162688
    s_branch L_poll1_out
L_posted:
    s_cmp_lt_u32 s3, 5
    s_cselect_b32 s55, 1, 0
    s_mov_b64 exec, 1
    s_waitcnt vmcnt(0)
    ds_add_u32 v14, v4 offset:8
    s_mov_b64 exec, -1
    s_branch L_setup3_end
L_setup3:
    v_lshrrev_b32 v216, 1, v1
    v_xor_b32 v216, v216, v1
    v_and_b32 v216, 4, v216
    v_mul_u32_u24 v216, 3, v216
    v_xor_b32 v216, v216, v1
    v_lshlrev_b32_e64 v244, 4, v216
    v_add_u32 v244, 145984, v244
    v_and_b32 v242, 15, v216
    v_lshlrev_b32 v242, 6, v242
    v_and_b32_e64 v216, 1, v3
    v_lshl_add_u32 v242, v216, 5, v242
    v_lshrrev_b32_e64 v216, 1, v3
    v_lshl_add_u32 v242, v216, 4, v242
    s_cmp_eq_u32 s55, 2
    s_cbranch_scc1 L_notab
    ds_read_b128 v[48:51], v244 offset:8192
    ds_read_b128 v[52:55], v244 offset:9216
    ds_read_b128 v[56:59], v244 offset:10240
    ds_read_b128 v[60:63], v244 offset:11264
    ds_read_b128 v[64:67], v244 offset:12288
    ds_read_b128 v[68:71], v244 offset:13312
    ds_read_b128 v[16:19], v244 offset:0
    ds_read_b128 v[32:35], v244 offset:4096
    ds_read_b128 v[20:23], v244 offset:1024
    ds_read_b128 v[36:39], v244 offset:5120
    ds_read_b128 v[24:27], v244 offset:2048
    ds_read_b128 v[40:43], v244 offset:6144
    ds_read_b128 v[28:31], v244 offset:3072
    ds_read_b128 v[44:47], v244 offset:7168
L_notab:
    v_lshrrev_b32_e64 v216, 2, v2
    v_lshl_add_u32 v216, v216, 7, s6
    v_cvt_f32_u32_e64 v216, v216
    v_mul_f32 v216, 0x3a000000, v216
    v_add_f32 v217, 0x3e800000, v216
    v_and_b32 v218, 1, v2
    v_cvt_f32_u32 v218, v218
    v_mul_f32 v218, 0xbe800000, v218
    v_add_f32 v219, 0xbe000000, v218
    v_add_f32 v218, 0x3e000000, v218
    v_and_b32 v220, 2, v2
    v_lshlrev_b32 v220, 30, v220
    v_xor_b32 v218, v220, v218
    v_xor_b32 v219, v220, v219
    v_lshlrev_b32 v220, 1, v3
    v_cvt_f32_u32 v220, v220
    v_add_f32_e64 v221, 1.0, v220
    v_add_f32 v222, 0x41000000, v220
    v_add_f32 v223, 0x41100000, v220
    v_fma_f32 v192, v216, v220, v218
    v_cos_f32 v193, v192
    v_sin_f32 v194, v192
    v_fma_f32 v195, v216, v221, v219
    v_cos_f32 v196, v195
    v_sin_f32 v197, v195
    v_fma_f32 v198, v216, v222, v218
    v_cos_f32 v199, v198
    v_sin_f32 v200, v198
    v_fma_f32 v201, v216, v223, v219
    v_cos_f32 v202, v201
    v_sin_f32 v203, v201
    v_fma_f32 v204, v217, v220, v218
    v_cos_f32 v205, v204
    v_sin_f32 v206, v204
    v_fma_f32 v207, v217, v221, v219
    v_cos_f32 v208, v207
    v_sin_f32 v209, v207
    v_fma_f32 v210, v217, v222, v218
    v_cos_f32 v211, v210
    v_sin_f32 v212, v210
    v_fma_f32 v213, v217, v223, v219
    v_cos_f32 v214, v213
    v_sin_f32 v215, v213
    v_cvt_pk_bf16_f32 v228, v193, -v194
    v_cvt_pk_bf16_f32 v229, v196, -v197
    v_cvt_pk_bf16_f32 v230, v199, -v200
    v_cvt_pk_bf16_f32 v231, v202, -v203
    v_cvt_pk_bf16_f32 v232, v205, -v206
    v_cvt_pk_bf16_f32 v233, v208, -v209
    v_cvt_pk_bf16_f32 v234, v211, -v212
    v_cvt_pk_bf16_f32 v235, v214, -v215
    v_lshrrev_b32 v216, 3, v1
    v_and_b32 v217, 3, v216
    v_lshlrev_b32_e64 v217, 6, v217
    v_lshl_add_u32 v216, v216, 8, v217
    v_and_b32_e64 v217, 3, v1
    v_lshl_add_u32 v216, v217, 4, v216
    v_and_b32_e64 v217, 4, v1
    v_lshl_add_u32 v216, v217, 1, v216
    v_add_u32 v246, s52, v216
    v_xor_b32 v247, 64, v246
    v_xor_b32 v248, 128, v246
    v_xor_b32 v249, 192, v246
    v_mul_u32_u24 v216, 4160, v3
    s_lshl_b32 s34, s3, 8
    s_add_u32 s35, s34, 32768
    s_sub_u32 s34, 36608, s34
    v_lshl_add_u32 v238, v2, 3, v216
    v_add_u32 v238, s35, v238
    v_sub_u32_e64 v217, 16, v2
    v_lshl_add_u32 v217, v217, 3, v216
    v_add_u32 v243, s34, v217
    v_cmp_eq_u32 vcc, 0, v2
    v_mov_b32 v218, 128
    v_mov_b32 v219, 132
    v_mov_b32 v220, -124
    v_cndmask_b32 v220, v218, v220, vcc
    v_cndmask_b32 v219, v219, v218, vcc
    v_add_u32 v239, v243, v220
    v_add_u32 v240, v243, v219
    s_mul_i32 s34, s31, 4160
    s_add_u32 s34, s34, 32768
    v_and_b32 v217, 31, v1
    v_lshrrev_b32 v218, 5, v1
    v_lshlrev_b32_e64 v219, 9, v218
    v_lshl_add_u32 v219, v217, 3, v219
    v_add_u32 v241, s34, v219
    s_lshl_b32 s96, s31, 7
    s_add_u32 s96, s96, s6
    s_lshl_b32 s96, s96, 12
    s_lshl_b32 s97, s4, 11
    s_add_u32 s96, s96, s97
    s_add_u32 s97, s96, 4194304
    s_mov_b32 s58, 0x05040100
    s_mov_b32 s59, 0x07060302
    v_lshlrev_b32 v216, 2, v3
    v_xor_b32 v216, v216, v2
    v_lshlrev_b32_e64 v216, 4, v216
    v_lshl_add_u32 v237, v3, 8, v216
    s_lshl_b32 s29, s4, 7
    s_add_u32 s29, s29, s5
    s_cmp_eq_u32 s55, 2
    s_cbranch_scc1 L_ret1
L_setup3_end:
    s_cmp_lg_u32 s55, 0
    s_cbranch_scc1 L_nosig2
    v_bfe_u32 v4, v1, 2, 2
    v_mul_u32_u24 v4, 8320, v4
    v_lshl_add_u32 v4, v3, 6, v4
    v_and_b32_e64 v5, 3, v1
    v_mul_u32_u24 v7, 260, v5
    v_add_u32 v7, 143936, v7
    v_lshrrev_b32 v6, 5, v1
    v_xor_b32 v5, v5, v6
    v_lshl_add_u32 v4, v5, 4, v4
    s_sub_u32 s42, 7, s3
    s_lshl_b32 s34, s42, 10
    s_add_u32 s34, s34, 74240
    v_add_u32 v4, s34, v4
    v_xor_b32 v5, 32, v4
    v_lshlrev_b32_e64 v6, 14, v3
    v_lshl_add_u32 v6, v2, 4, v6
    s_lshl3_add_u32 s34, s32, s42
    s_mul_i32 s34, s34, 256
    s_add_u32 s34, s34, s30
    s_add_u32 s34, s34, 8192
    s_lshr_b32 s38, s42, 1
    s_and_b32 s40, s42, 1
    s_lshl_b32 s40, s40, 6
    s_add_u32 s38, s38, s40
    s_lshl_b32 s38, s38, 12
    s_add_u32 s38, s38, s44
    s_mov_b32 s33, 0x40000
L_pg0:
    ds_read_b32 v15, v7
    s_sub_u32 s33, s33, 1
    s_cbranch_scc1 L_pg0_out
    s_waitcnt lgkmcnt(0)
    v_cmp_ge_u32 vcc, s42, v15
    s_nop 1
    s_and_b64 vcc, vcc, vcc
    s_cbranch_scc1 L_pg0
L_pg0_out:
    s_nop 0
    ds_read_b128 v[128:131], v4 offset:0
    ds_read_b128 v[132:135], v5 offset:256
    ds_read_b128 v[136:139], v4 offset:512
    ds_read_b128 v[140:143], v5 offset:768
    s_add_u32 s42, s42, 3
    s_waitcnt lgkmcnt(3)
    buffer_store_dwordx4 v[128:131], v6, s[20:23], s38 offen sc1
    s_add_u32 s38, s38, 65536
    s_xor_b32 s38, s38, 2097152
    s_nop 0
    s_waitcnt lgkmcnt(2)
    buffer_store_dwordx4 v[132:135], v6, s[20:23], s38 offen sc1
    s_add_u32 s38, s38, 65536
    s_xor_b32 s38, s38, 2097152
    s_nop 0
    s_waitcnt lgkmcnt(1)
    buffer_store_dwordx4 v[136:139], v6, s[20:23], s38 offen sc1
    s_add_u32 s38, s38, 65536
    s_xor_b32 s38, s38, 2097152
    s_waitcnt lgkmcnt(0)
    buffer_store_dwordx4 v[140:143], v6, s[20:23], s38 offen sc1
    s_lshr_b32 s38, s42, 1
    s_and_b32 s40, s42, 1
    s_lshl_b32 s40, s40, 6
    s_add_u32 s38, s38, s40
    s_lshl_b32 s38, s38, 12
    s_add_u32 s38, s38, s44
    s_mov_b32 s33, 0x40000
L_pg1:
    ds_read_b32 v15, v7
    s_sub_u32 s33, s33, 1
    s_cbranch_scc1 L_pg1_out
    s_waitcnt lgkmcnt(0)
    v_cmp_ge_u32 vcc, s42, v15
    s_nop 1
    s_and_b64 vcc, vcc, vcc
    s_cbranch_scc1 L_pg1
L_pg1_out:
    ds_read_b128 v[144:147], v4 offset:3072
    ds_read_b128 v[148:151], v5 offset:3328
    ds_read_b128 v[152:155], v4 offset:3584
    ds_read_b128 v[156:159], v5 offset:3840
    s_add_u32 s42, s42, 3
    s_waitcnt lgkmcnt(3)
    buffer_store_dwordx4 v[144:147], v6, s[20:23], s38 offen sc1
    s_add_u32 s38, s38, 65536
    s_xor_b32 s38, s38, 2097152
    s_nop 0
    s_waitcnt lgkmcnt(2)
    buffer_store_dwordx4 v[148:151], v6, s[20:23], s38 offen sc1
    s_add_u32 s38, s38, 65536
    s_xor_b32 s38, s38, 2097152
    s_nop 0
    s_waitcnt lgkmcnt(1)
    buffer_store_dwordx4 v[152:155], v6, s[20:23], s38 offen sc1
    s_add_u32 s38, s38, 65536
    s_xor_b32 s38, s38, 2097152
    s_waitcnt lgkmcnt(0)
    buffer_store_dwordx4 v[156:159], v6, s[20:23], s38 offen sc1
    s_cmp_ge_u32 s42, 8
    s_cbranch_scc1 L_short
    s_lshr_b32 s38, s42, 1
    s_and_b32 s40, s42, 1
    s_lshl_b32 s40, s40, 6
    s_add_u32 s38, s38, s40
    s_lshl_b32 s38, s38, 12
    s_add_u32 s38, s38, s44
    s_mov_b32 s33, 0x40000
L_pg2:
    ds_read_b32 v15, v7
    s_sub_u32 s33, s33, 1
    s_cbranch_scc1 L_pg2_out
    s_waitcnt lgkmcnt(0)
    v_cmp_ge_u32 vcc, s42, v15
    s_nop 1
    s_and_b64 vcc, vcc, vcc
    s_cbranch_scc1 L_pg2
L_pg2_out:
    ds_read_b128 v[160:163], v4 offset:6144
    ds_read_b128 v[164:167], v5 offset:6400
    ds_read_b128 v[168:171], v4 offset:6656
    ds_read_b128 v[172:175], v5 offset:6912
    s_add_u32 s42, s42, 3
    s_waitcnt lgkmcnt(3)
    buffer_store_dwordx4 v[160:163], v6, s[20:23], s38 offen sc1
    s_add_u32 s38, s38, 65536
    s_xor_b32 s38, s38, 2097152
    s_nop 0
    s_waitcnt lgkmcnt(2)
    buffer_store_dwordx4 v[164:167], v6, s[20:23], s38 offen sc1
    s_add_u32 s38, s38, 65536
    s_xor_b32 s38, s38, 2097152
    s_nop 0
    s_waitcnt lgkmcnt(1)
    buffer_store_dwordx4 v[168:171], v6, s[20:23], s38 offen sc1
    s_add_u32 s38, s38, 65536
    s_xor_b32 s38, s38, 2097152
    s_waitcnt lgkmcnt(0)
    buffer_store_dwordx4 v[172:175], v6, s[20:23], s38 offen sc1
    s_waitcnt vmcnt(8)
    s_atomic_add s100, s[24:25], s34
    s_waitcnt vmcnt(4)
    s_atomic_add s100, s[24:25], s34 offset:768
    s_waitcnt vmcnt(0)
    s_atomic_add s100, s[24:25], s34 offset:1536
    s_branch L_nosig2
L_short:
    s_waitcnt vmcnt(4)
    s_atomic_add s100, s[24:25], s34
    s_waitcnt vmcnt(0)
    s_atomic_add s100, s[24:25], s34 offset:768
L_nosig2:
    s_barrier
    s_mov_b32 m0, s52
    s_mov_b32 s50, 16
    s_mov_b32 s33, 0x8000
L_poll2:
    s_mov_b64 s[48:49], 0
    s_atomic_or_x2 s[48:49], s[24:25], s57 glc
    s_sub_u32 s33, s33, 1
    s_cbranch_scc1 L_poll2_out
    s_waitcnt lgkmcnt(0)
    s_cmp_eq_u64 s[48:49], s[50:51]
    s_cbranch_scc0 L_poll2
L_poll2_out:
    buffer_load_dwordx4 v237, s[20:23], s96 offen offset:0 sc1 lds
    buffer_load_dwordx4 v237, s[20:23], s96 offen offset:1024 sc1 lds
    s_add_u32 m0, m0, 2048
    s_nop 0
    buffer_load_dwordx4 v237, s[20:23], s97 offen offset:0 sc1 lds
    buffer_load_dwordx4 v237, s[20:23], s97 offen offset:1024 sc1 lds
    s_cmp_lg_u32 s3, 4
    s_cbranch_scc1 L_noep
    s_cmp_lg_u32 s2, 161
    s_cbranch_scc1 L_noep
    s_mov_b32 s38, 655360
    s_atomic_swap s51, s[24:25], s38
    s_waitcnt lgkmcnt(0)
L_noep:
    s_cmp_lg_u32 s3, 0
    s_cbranch_scc1 L_nosp3a
    s_lshl_b32 s38, s29, 7
    s_add_u32 s38, s38, 196608
    s_load_dwordx16 s[60:75], s[24:25], s38 offset:0 glc
    s_load_dwordx16 s[76:91], s[24:25], s38 offset:64 glc
L_nosp3a:
    v_perm_b32 v80, v64, v48, s58
    v_perm_b32 v96, v48, v56, s58
    v_perm_b32 v81, v64, v48, s59
    v_perm_b32 v97, v48, v56, s59
    v_perm_b32 v82, v65, v49, s58
    v_perm_b32 v98, v49, v57, s58
    v_perm_b32 v83, v65, v49, s59
    v_perm_b32 v99, v49, v57, s59
    v_perm_b32 v84, v66, v50, s58
    v_perm_b32 v100, v50, v58, s58
    v_perm_b32 v85, v66, v50, s59
    v_perm_b32 v101, v50, v58, s59
    v_perm_b32 v86, v67, v51, s58
    v_perm_b32 v102, v51, v59, s58
    v_perm_b32 v87, v67, v51, s59
    v_perm_b32 v103, v51, v59, s59
    v_perm_b32 v88, v68, v52, s58
    v_perm_b32 v104, v52, v60, s58
    v_perm_b32 v89, v68, v52, s59
    v_perm_b32 v105, v52, v60, s59
    v_perm_b32 v90, v69, v53, s58
    v_perm_b32 v106, v53, v61, s58
    v_perm_b32 v91, v69, v53, s59
    v_perm_b32 v107, v53, v61, s59
    v_perm_b32 v92, v70, v54, s58
    v_perm_b32 v108, v54, v62, s58
    v_perm_b32 v93, v70, v54, s59
    v_perm_b32 v109, v54, v62, s59
    v_perm_b32 v94, v71, v55, s58
    v_perm_b32 v110, v55, v63, s58
    v_perm_b32 v95, v71, v55, s59
    v_perm_b32 v111, v55, v63, s59
    s_cmp_lg_u32 s3, 0
    s_cbranch_scc1 L_nosp3b
    s_mov_b32 s33, 0x8000
    s_branch L_gchk
L_gagain:
    s_sub_u32 s33, s33, 1
    s_cbranch_scc1 L_gok
    s_load_dwordx16 s[60:75], s[24:25], s38 offset:0 glc
    s_load_dwordx16 s[76:91], s[24:25], s38 offset:64 glc
L_gchk:
    s_waitcnt lgkmcnt(0)
    s_cmp_lg_u32 s61, s51
    s_cbranch_scc1 L_gagain
    s_cmp_lg_u32 s63, s51
    s_cbranch_scc1 L_gagain
    s_cmp_lg_u32 s65, s51
    s_cbranch_scc1 L_gagain
    s_cmp_lg_u32 s67, s51
    s_cbranch_scc1 L_gagain
    s_cmp_lg_u32 s69, s51
    s_cbranch_scc1 L_gagain
    s_cmp_lg_u32 s71, s51
    s_cbranch_scc1 L_gagain
    s_cmp_lg_u32 s73, s51
    s_cbranch_scc1 L_gagain
    s_cmp_lg_u32 s75, s51
    s_cbranch_scc1 L_gagain
    s_cmp_lg_u32 s77, s51
    s_cbranch_scc1 L_gagain
    s_cmp_lg_u32 s79, s51
    s_cbranch_scc1 L_gagain
    s_cmp_lg_u32 s81, s51
    s_cbranch_scc1 L_gagain
    s_cmp_lg_u32 s83, s51
    s_cbranch_scc1 L_gagain
    s_cmp_lg_u32 s85, s51
    s_cbranch_scc1 L_gagain
    s_cmp_lg_u32 s87, s51
    s_cbranch_scc1 L_gagain
    s_cmp_lg_u32 s89, s51
    s_cbranch_scc1 L_gagain
    s_cmp_lg_u32 s91, s51
    s_cbranch_scc1 L_gagain
L_gok:
    v_writelane_b32 v196, s60, 0
    v_writelane_b32 v197, s62, 0
    v_writelane_b32 v196, s64, 16
    v_writelane_b32 v197, s66, 16
    v_writelane_b32 v196, s68, 32
    v_writelane_b32 v197, s70, 32
    v_writelane_b32 v196, s72, 48
    v_writelane_b32 v197, s74, 48
    v_writelane_b32 v198, s76, 0
    v_writelane_b32 v199, s78, 0
    v_writelane_b32 v198, s80, 16
    v_writelane_b32 v199, s82, 16
    v_writelane_b32 v198, s84, 32
    v_writelane_b32 v199, s86, 32
    v_writelane_b32 v198, s88, 48
    v_writelane_b32 v199, s90, 48
    s_nop 1
    v_mfma_f32_16x16x32_bf16 v[160:163], v[228:231], v[196:199], 0
    v_mfma_f32_16x16x32_bf16 v[164:167], v[232:235], v[196:199], 0
L_nosp3b:
    s_waitcnt vmcnt(0)
    ds_read_b64_tr_b16 v[116:117], v247 offset:0
    ds_read_b64_tr_b16 v[118:119], v247 offset:2048
    ds_read_b64_tr_b16 v[124:125], v249 offset:0
    ds_read_b64_tr_b16 v[126:127], v249 offset:2048
    ds_read_b64_tr_b16 v[112:113], v246 offset:0
    ds_read_b64_tr_b16 v[114:115], v246 offset:2048
    ds_read_b64_tr_b16 v[120:121], v248 offset:0
    ds_read_b64_tr_b16 v[122:123], v248 offset:2048
    s_nop 0
    s_waitcnt lgkmcnt(6)
    v_mfma_f32_16x16x32_bf16 v[136:139], v[228:231], v[116:119], 0
    v_mfma_f32_16x16x32_bf16 v[140:143], v[232:235], v[116:119], 0
    s_nop 0
    s_waitcnt lgkmcnt(4)
    v_mfma_f32_16x16x32_bf16 v[152:155], v[228:231], v[124:127], 0
    v_mfma_f32_16x16x32_bf16 v[156:159], v[232:235], v[124:127], 0
    s_nop 0
    s_waitcnt lgkmcnt(2)
    v_mfma_f32_16x16x32_bf16 v[128:131], v[228:231], v[112:115], 0
    v_mfma_f32_16x16x32_bf16 v[132:135], v[232:235], v[112:115], 0
    s_nop 0
    s_waitcnt lgkmcnt(0)
    v_mfma_f32_16x16x32_bf16 v[144:147], v[228:231], v[120:123], 0
    v_mfma_f32_16x16x32_bf16 v[148:151], v[232:235], v[120:123], 0
    v_cvt_pk_bf16_f32 v208, v136, v137
    v_cvt_pk_bf16_f32 v211, v138, v139
    v_cvt_pk_bf16_f32 v209, v152, v153
    v_cvt_pk_bf16_f32 v210, v154, v155
    v_cvt_pk_bf16_f32 v212, v140, v141
    v_cvt_pk_bf16_f32 v215, v142, v143
    v_cvt_pk_bf16_f32 v213, v156, v157
    v_cvt_pk_bf16_f32 v214, v158, v159
    ds_write_b64 v238, v[208:209] offset:128
    ds_write_b64 v243, v[210:211] offset:0
    ds_write_b64 v238, v[212:213] offset:16768
    ds_write_b64 v243, v[214:215] offset:16640
    s_cmp_lg_u32 s3, 0
    s_cbranch_scc1 L_nofix
    s_mov_b32 exec_lo, 0x00010001
    s_mov_b32 exec_hi, 0x00010001
    v_add_f32 v160, v160, v162
    v_mul_f32 v160, 0.5, v160
    v_add_f32 v161, v161, v163
    v_mul_f32 v161, 0.5, v161
    v_add_f32 v164, v164, v166
    v_mul_f32 v164, 0.5, v164
    v_add_f32 v165, v165, v167
    v_mul_f32 v165, 0.5, v165
    v_add_f32 v128, v128, v130
    v_mul_f32 v128, 0.5, v128
    v_add_f32 v129, v129, v131
    v_mul_f32 v129, 0.5, v129
    v_add_f32 v132, v132, v134
    v_mul_f32 v132, 0.5, v132
    v_add_f32 v133, v133, v135
    v_mul_f32 v133, 0.5, v133
    v_cvt_pk_bf16_f32 v192, v160, v161
    v_cvt_pk_bf16_f32 v193, v164, v165
    ds_write_b32 v238, v192 offset:2048
    ds_write_b32 v238, v193 offset:18688
    s_mov_b64 exec, -1
L_nofix:
    s_nop 0
    v_cvt_pk_bf16_f32 v200, v128, v129
    v_cvt_pk_bf16_f32 v203, v130, v131
    v_cvt_pk_bf16_f32 v201, v144, v145
    v_cvt_pk_bf16_f32 v202, v146, v147
    v_cvt_pk_bf16_f32 v204, v132, v133
    v_cvt_pk_bf16_f32 v207, v134, v135
    v_cvt_pk_bf16_f32 v205, v148, v149
    v_cvt_pk_bf16_f32 v206, v150, v151
    ds_write_b64 v238, v[200:201] offset:0
    ds_write_b32 v239, v202 offset:0
    ds_write_b32 v240, v203 offset:0
    ds_write_b64 v238, v[204:205] offset:16640
    ds_write_b32 v239, v206 offset:16640
    ds_write_b32 v240, v207 offset:16640
    s_waitcnt lgkmcnt(0)
    s_barrier
    ds_read_b64 v[112:113], v241 offset:0
    ds_read_b64 v[114:115], v241 offset:256
    ds_read_b64 v[116:117], v241 offset:1024
    ds_read_b64 v[118:119], v241 offset:1280
    ds_read_b64 v[120:121], v241 offset:2048
    ds_read_b64 v[122:123], v241 offset:2304
    ds_read_b64 v[124:125], v241 offset:3072
    ds_read_b64 v[126:127], v241 offset:3328
    s_waitcnt lgkmcnt(6)
    v_mfma_f32_32x32x16_bf16 v[128:143], v[112:115], v[80:83], 0
    s_waitcnt lgkmcnt(4)
    v_mfma_f32_32x32x16_bf16 v[128:143], v[116:119], v[84:87], v[128:143]
    s_waitcnt lgkmcnt(2)
    v_mfma_f32_32x32x16_bf16 v[128:143], v[120:123], v[88:91], v[128:143]
    s_waitcnt lgkmcnt(0)
    v_mfma_f32_32x32x16_bf16 v[128:143], v[124:127], v[92:95], v[128:143]
    s_nop 4
    v_mfma_f32_32x32x16_bf16 v[144:159], v[112:115], v[96:99], 0
    s_nop 4
    v_mfma_f32_32x32x16_bf16 v[144:159], v[116:119], v[100:103], v[144:159]
    v_mul_f32_e64 v192, -v128, v16
    v_mul_f32_e64 v208, v128, v32
    v_mul_f32_e64 v193, -v129, v17
    v_mul_f32_e64 v209, v129, v33
    v_mul_f32_e64 v194, -v130, v18
    v_mul_f32_e64 v210, v130, v34
    v_mfma_f32_32x32x16_bf16 v[144:159], v[120:123], v[104:107], v[144:159]
    v_mul_f32_e64 v195, -v131, v19
    v_mul_f32_e64 v211, v131, v35
    v_mul_f32_e64 v196, -v132, v20
    v_mul_f32_e64 v212, v132, v36
    v_mul_f32_e64 v197, -v133, v21
    v_mul_f32_e64 v213, v133, v37
    v_mfma_f32_32x32x16_bf16 v[144:159], v[124:127], v[108:111], v[144:159]
    v_mul_f32_e64 v198, -v134, v22
    v_mul_f32_e64 v214, v134, v38
    v_mul_f32_e64 v199, -v135, v23
    v_mul_f32_e64 v215, v135, v39
    v_mul_f32_e64 v200, -v136, v24
    v_mul_f32_e64 v216, v136, v40
    v_mul_f32_e64 v201, -v137, v25
    v_mul_f32_e64 v217, v137, v41
    v_mul_f32_e64 v202, -v138, v26
    v_mul_f32_e64 v218, v138, v42
    v_mul_f32_e64 v203, -v139, v27
    v_mul_f32_e64 v219, v139, v43
    v_mul_f32_e64 v204, -v140, v28
    v_mul_f32_e64 v220, v140, v44
    v_mul_f32_e64 v205, -v141, v29
    v_mul_f32_e64 v221, v141, v45
    v_mul_f32_e64 v206, -v142, v30
    v_mul_f32_e64 v222, v142, v46
    v_mul_f32_e64 v207, -v143, v31
    v_mul_f32 v223, v143, v47
    v_fmac_f32 v192, v144, v32
    v_fmac_f32 v208, v144, v16
    v_fmac_f32 v193, v145, v33
    v_fmac_f32_e64 v209, v145, v17
    v_cvt_pk_bf16_f32 v112, -v192, -v193
    v_cvt_pk_bf16_f32 v120, v208, v209
    v_fmac_f32 v194, v146, v34
    v_fmac_f32 v210, v146, v18
    v_fmac_f32 v195, v147, v35
    v_fmac_f32 v211, v147, v19
    v_cvt_pk_bf16_f32 v113, -v194, -v195
    v_cvt_pk_bf16_f32 v121, v210, v211
    v_fmac_f32 v196, v148, v36
    v_fmac_f32 v212, v148, v20
    v_fmac_f32 v197, v149, v37
    v_fmac_f32 v213, v149, v21
    v_cvt_pk_bf16_f32 v114, -v196, -v197
    v_cvt_pk_bf16_f32 v122, v212, v213
    v_fmac_f32 v198, v150, v38
    v_fmac_f32 v214, v150, v22
    v_fmac_f32 v199, v151, v39
    v_fmac_f32 v215, v151, v23
    v_cvt_pk_bf16_f32 v115, -v198, -v199
    v_cvt_pk_bf16_f32 v123, v214, v215
    s_nop 0
    v_mfma_f32_32x32x16_bf16 v[160:175], v[112:115], v[48:51], 0
    v_fmac_f32 v200, v152, v40
    v_fmac_f32 v216, v152, v24
    v_fmac_f32 v201, v153, v41
    v_fmac_f32_e64 v217, v153, v25
    v_cvt_pk_bf16_f32 v116, -v200, -v201
    v_cvt_pk_bf16_f32 v124, v216, v217
    v_mfma_f32_32x32x16_bf16 v[160:175], v[120:123], v[64:67], v[160:175]
    v_fmac_f32 v202, v154, v42
    v_fmac_f32 v218, v154, v26
    v_fmac_f32 v203, v155, v43
    v_fmac_f32 v219, v155, v27
    v_cvt_pk_bf16_f32 v117, -v202, -v203
    v_cvt_pk_bf16_f32 v125, v218, v219
    v_mfma_f32_32x32x16_bf16 v[176:191], v[112:115], v[56:59], 0
    v_fmac_f32 v204, v156, v44
    v_fmac_f32 v220, v156, v28
    v_fmac_f32 v205, v157, v45
    v_fmac_f32 v221, v157, v29
    v_cvt_pk_bf16_f32 v118, -v204, -v205
    v_cvt_pk_bf16_f32 v126, v220, v221
    v_mfma_f32_32x32x16_bf16 v[176:191], v[120:123], v[48:51], v[176:191]
    v_fmac_f32 v206, v158, v46
    v_fmac_f32 v222, v158, v30
    v_fmac_f32 v207, v159, v47
    v_fmac_f32 v223, v159, v31
    v_cvt_pk_bf16_f32 v119, -v206, -v207
    v_cvt_pk_bf16_f32 v127, v222, v223
    s_nop 0
    v_mfma_f32_32x32x16_bf16 v[160:175], v[116:119], v[52:55], v[160:175]
    v_mfma_f32_32x32x16_bf16 v[160:175], v[124:127], v[68:71], v[160:175]
    s_nop 4
    v_mfma_f32_32x32x16_bf16 v[176:191], v[116:119], v[60:63], v[176:191]
    s_nop 4
    s_nop 0
    v_mfma_f32_32x32x16_bf16 v[176:191], v[124:127], v[52:55], v[176:191]
    v_cvt_pk_bf16_f32 v192, v160, v161
    v_cvt_pk_bf16_f32 v196, v168, v169
    v_cvt_pk_bf16_f32 v193, v162, v163
    v_cvt_pk_bf16_f32 v197, v170, v171
    v_cvt_pk_bf16_f32 v194, v164, v165
    v_cvt_pk_bf16_f32 v198, v172, v173
    v_cvt_pk_bf16_f32 v195, v166, v167
    v_cvt_pk_bf16_f32 v199, v174, v175
    v_permlane16_swap_b32 v192, v196
    v_permlane16_swap_b32 v193, v197
    v_permlane16_swap_b32 v194, v198
    v_permlane16_swap_b32 v195, v199
    buffer_store_dwordx4 v[192:195], v242, s[20:23], s96 offen offset:0 sc1
    buffer_store_dwordx4 v[196:199], v242, s[20:23], s96 offen offset:1024 sc1
    v_cvt_pk_bf16_f32 v200, v176, v177
    v_cvt_pk_bf16_f32 v204, v184, v185
    v_cvt_pk_bf16_f32 v201, v178, v179
    v_cvt_pk_bf16_f32 v205, v186, v187
    v_cvt_pk_bf16_f32 v202, v180, v181
    v_cvt_pk_bf16_f32 v206, v188, v189
    v_cvt_pk_bf16_f32 v203, v182, v183
    v_cvt_pk_bf16_f32 v207, v190, v191
    v_permlane16_swap_b32 v200, v204
    v_permlane16_swap_b32 v201, v205
    v_permlane16_swap_b32 v202, v206
    v_permlane16_swap_b32 v203, v207
    buffer_store_dwordx4 v[200:203], v242, s[20:23], s97 offen offset:0 sc1
    buffer_store_dwordx4 v[204:207], v242, s[20:23], s97 offen offset:1024 sc1
L_end:
    s_endpgm
.section .rodata,"a"
.p2align 6
.amdhsa_kernel concat_heads__spectral_gfnet__spectral_gfnet__prompt_kernel
  .amdhsa_next_free_vgpr 256
  .amdhsa_next_free_sgpr 102
  .amdhsa_accum_offset 256
  .amdhsa_group_segment_fixed_size 0
  .amdhsa_kernarg_size 72
  .amdhsa_user_sgpr_count 2
  .amdhsa_user_sgpr_kernarg_segment_ptr 1
  .amdhsa_system_sgpr_workgroup_id_x 1
  .amdhsa_float_denorm_mode_32 3
.end_amdhsa_kernel
```
